```python
import torch

def _softmax(x, axis=-1):
    return torch.softmax(x, dim=axis)
def _gelu(x):
    return torch.nn.functional.gelu(x, approximate="tanh")
def _silu(x):
    return torch.nn.functional.silu(x)
def _sigmoid(x):
    return torch.sigmoid(x)
def _layernorm(x, axis=-1, eps=1e-5):
    m = x.mean(dim=axis, keepdim=True)
    v = x.var(dim=axis, keepdim=True, unbiased=False)
    return (x - m) / torch.sqrt(v + eps)
def _scatter_add(tgt, idx, src, axis=0):
    return tgt.clone().index_add_(axis, idx, src)
def _segment_sum(src, seg, n):
    out = torch.zeros((n,) + src.shape[1:], dtype=src.dtype)
    return out.index_add_(0, seg, src)
def _pad(x, pw):
    flat = tuple(v for pair in reversed(pw) for v in pair)
    return torch.nn.functional.pad(x, flat)

kernel_name = 'recurrent_scan__softmax_full_mha__glu_gated_geglu__prompt'

def setup_inputs():

    _w = (lambda a: (lambda t: t.to(torch.bfloat16) if t.is_floating_point() else t)(torch.as_tensor(a)))
    def _A_setup():
        B, S, D = 1, 2048, 512
        return {
            "x": _w((lambda *s: torch.randn(*s, dtype=torch.bfloat16) * 0.05)(B, S, D)),
            "wqkv": _w((lambda *s: torch.randn(*s, dtype=torch.bfloat16) * 0.2)(D, 3 * D)),
            "wo": _w((lambda *s: torch.randn(*s, dtype=torch.bfloat16) * 0.2)(D, D)),
        }
    _A_in = _A_setup()

    def _B_setup():
        B, S, Dm, Df = 1, 2048, 512, 1376
        return {
            "x": _w((lambda *s: torch.randn(*s, dtype=torch.bfloat16) * 0.05)(B, S, Dm)),
            "w_gate": _w((lambda *s: torch.randn(*s, dtype=torch.bfloat16) * 0.1)(Dm, Df) * (Dm ** -0.5)),
            "w_up": _w((lambda *s: torch.randn(*s, dtype=torch.bfloat16) * 0.1)(Dm, Df) * (Dm ** -0.5)),
            "w_down": _w((lambda *s: torch.randn(*s, dtype=torch.bfloat16) * 0.1)(Df, Dm) * (Df ** -0.5)),
        }
    _B_in = _B_setup()

    return {
        "A_x": _A_in["x"],
        "A_wqkv": _A_in["wqkv"],
        "A_wo": _A_in["wo"],
        "B_x": _B_in["x"],
        "B_w_gate": _B_in["w_gate"],
        "B_w_up": _B_in["w_up"],
        "B_w_down": _B_in["w_down"],
    }

def reference(A_x, A_wqkv, A_wo, B_x, B_w_gate, B_w_up, B_w_down):
    def _A_ref(x, wqkv, wo):
        B, S, D = x.shape
        H = 32; Dh = D // H
        qkv = (lambda x, *d: x.permute(*d))((x @ wqkv).reshape(B, S, 3, H, Dh), 2, 0, 3, 1, 4)
        q, k, v = qkv[0], qkv[1], qkv[2]
        scale = Dh ** -0.5
        scores = torch.einsum("bhqd,bhkd->bhqk", q, k) * scale
        p = _softmax(scores, axis=-1)
        o = torch.einsum("bhqk,bhkd->bhqd", p, v)
        return (lambda x, *d: x.permute(*d))(o, 0, 2, 1, 3).reshape(B, S, D) @ wo

    def _B_ref(x, w_gate, w_up, w_down):
        g = torch.einsum("bsd,df->bsf", x, w_gate)
        u = torch.einsum("bsd,df->bsf", x, w_up)
        h = _gelu(g) * u
        return torch.einsum("bsf,fd->bsd", h, w_down)

    x = A_x
    xn = _layernorm(x, axis=-1)
    s = _A_ref(xn, A_wqkv, A_wo)
    g = _silu(_B_ref(xn, B_w_gate, B_w_up, B_w_down))
    return x + s * g
```

```asm
; @launch grid=(256,1,1) block=(512,1,1) lds=163840
.amdgcn_target "amdgcn-amd-amdhsa--gfx950"
.text
.globl recurrent_scan__softmax_full_mha__glu_gated_geglu__prompt_kernel
.p2align 8
.type recurrent_scan__softmax_full_mha__glu_gated_geglu__prompt_kernel,@function
recurrent_scan__softmax_full_mha__glu_gated_geglu__prompt_kernel:
    s_cmp_ge_u32 s2, 256
    s_cbranch_scc1 L_END
    s_load_dwordx4 s[4:7], s[0:1], 0
    s_load_dwordx2 s[8:9], s[0:1], 16
    s_load_dwordx4 s[12:15], s[0:1], 32
    s_load_dwordx4 s[52:55], s[0:1], 48
    s_load_dwordx4 s[56:59], s[0:1], 64
    s_getpc_b64 s[60:61]
L_PC:
    s_lshr_b32 s23, s2, 3
    s_lshl_b32 s62, s23, 11
    v_lshl_add_u32 v250, v0, 7, s62
    v_cmp_gt_u32 s[62:63], 16, v0
    v_cmp_gt_u32 vcc, L_CODE_END-L_PC-4, v250
    v_lshrrev_b32 v252, 6, v0
    v_and_b32 v254, 63, v0
    s_and_b64 exec, vcc, s[62:63]
    s_cbranch_execz L_NOPF
    v_mov_b32 v251, s61
    v_add_co_u32 v250, vcc, s60, v250
    v_addc_co_u32 v251, vcc, 0, v251, vcc
    global_load_dword v253, v[250:251], off
L_NOPF:
    s_mov_b64 exec, -1
    v_readfirstlane_b32 s22, v252
    v_lshrrev_b32 v232, 3, v254
    v_and_b32 v233, 7, v254
    v_lshlrev_b32 v212, 10, v232
    v_lshl_add_u32 v212, v233, 4, v212
    s_bfe_u32 s20, s2, 0x20001
    s_lshl_b32 s20, s20, 2
    s_and_b32 s60, s23, 3
    s_add_u32 s20, s20, s60
    s_cmp_lt_u32 s22, 4
    s_cbranch_scc1 L_COMMON
    s_sub_u32 s60, s22, 4
    s_lshl_b32 s61, s20, 17
    s_lshl_b32 s62, s60, 15
    s_add_u32 s61, s61, s62
    s_lshr_b32 s80, s2, 5
    s_waitcnt lgkmcnt(0)
    s_mov_b32 s24, s4
    s_mov_b32 s25, s5
    s_mov_b32 s26, 0x200000
    s_mov_b32 s27, 0x00020000
    s_add_u32 s85, s80, 0
    s_and_b32 s85, s85, 3
    s_lshl_b32 s89, s85, 13
    s_add_u32 s89, s89, s61
    buffer_load_dwordx4 v[0:3], v212, s[24:27], s89 offen offset:0
    buffer_load_dwordx4 v[4:7], v212, s[24:27], s89 offen offset:128
    buffer_load_dwordx4 v[8:11], v212, s[24:27], s89 offen offset:256
    buffer_load_dwordx4 v[12:15], v212, s[24:27], s89 offen offset:384
    buffer_load_dwordx4 v[16:19], v212, s[24:27], s89 offen offset:512
    buffer_load_dwordx4 v[20:23], v212, s[24:27], s89 offen offset:640
    buffer_load_dwordx4 v[24:27], v212, s[24:27], s89 offen offset:768
    buffer_load_dwordx4 v[28:31], v212, s[24:27], s89 offen offset:896
    s_add_u32 s86, s80, 1
    s_and_b32 s86, s86, 3
    s_lshl_b32 s89, s86, 13
    s_add_u32 s89, s89, s61
    buffer_load_dwordx4 v[32:35], v212, s[24:27], s89 offen offset:0
    buffer_load_dwordx4 v[36:39], v212, s[24:27], s89 offen offset:128
    buffer_load_dwordx4 v[40:43], v212, s[24:27], s89 offen offset:256
    buffer_load_dwordx4 v[44:47], v212, s[24:27], s89 offen offset:384
    buffer_load_dwordx4 v[48:51], v212, s[24:27], s89 offen offset:512
    buffer_load_dwordx4 v[52:55], v212, s[24:27], s89 offen offset:640
    buffer_load_dwordx4 v[56:59], v212, s[24:27], s89 offen offset:768
    buffer_load_dwordx4 v[60:63], v212, s[24:27], s89 offen offset:896
L_COMMON:
    s_lshr_b32 s62, s23, 2
    s_and_b32 s63, s2, 1
    s_lshl_b32 s21, s62, 1
    s_add_u32 s21, s21, s63
    s_mul_i32 s63, s63, 5
    s_add_u32 s63, s63, s62
    s_add_u32 s63, s63, 3
    s_cmp_ge_u32 s62, 3
    s_cselect_b32 s21, s63, s21
    s_waitcnt lgkmcnt(0)
    s_mov_b32 s24, s4
    s_mov_b32 s25, s5
    s_mov_b32 s26, 0x200000
    s_mov_b32 s27, 0x00020000
    s_mov_b64 s[16:17], s[52:53]
    s_mov_b64 s[18:19], s[58:59]
    s_mov_b32 s32, s58
    s_mov_b32 s33, s59
    s_mov_b32 s34, 0x1200000
    s_mov_b32 s35, 0x00020000
    s_mov_b32 s36, s56
    s_mov_b32 s37, s57
    s_mov_b32 s38, 0x100
    s_mov_b32 s39, 0x00020000
    s_mov_b32 s40, s54
    s_mov_b32 s41, s55
    s_mov_b32 s42, 0x200000
    s_mov_b32 s43, 0x00020000
    s_mov_b32 s44, s58
    s_mov_b32 s45, s59
    s_mov_b32 s46, 0x0
    s_mov_b32 s47, 0x00020000
    s_mov_b32 s48, s58
    s_mov_b32 s49, s59
    s_mov_b32 s50, 0x0
    s_mov_b32 s51, 0x00020000
    s_mov_b32 s52, 0x7fff0000
    s_mov_b32 s53, 0x7fff0000
    s_mov_b32 s54, 0x7fff0000
    s_mov_b32 s55, 0x7fff0000
    s_mov_b32 s56, 0x7fff0000
    s_mov_b32 s57, 0x7fff0000
    s_mov_b32 s58, 0x7fff0000
    s_mov_b32 s59, 0x7fff0000
    s_mov_b32 s10, 0x7fff0000
    s_cmp_lt_u32 s22, 4
    s_cbranch_scc1 L_COMPUTE
    s_bfe_u32 s62, s22, 0x10001
    s_and_b32 s63, s22, 1
    s_cmp_lt_u32 s21, 6
    s_cbranch_scc1 LL_Q
    s_cmp_eq_u32 s63, 0
    s_cselect_b32 s28, s12, s14
    s_cselect_b32 s29, s13, s15
    s_mov_b32 s30, 0x158000
    s_sub_u32 s64, s21, 6
    s_mul_i32 s64, s64, 288
    s_mov_b32 s65, 2464
    v_mul_u32_u24 v160, 3641, v254
    v_lshl_add_u32 v161, v254, 4, s64
    v_add_u32 v162, 0, v160
    v_lshrrev_b32 v162, 16, v162
    v_add_u32 v163, 0, v161
    v_mad_u32_u24 v144, v162, s65, v163
    v_add_u32 v162, 233024, v160
    v_lshrrev_b32 v162, 16, v162
    v_add_u32 v163, 1024, v161
    v_mad_u32_u24 v145, v162, s65, v163
    v_add_u32 v162, 466048, v160
    v_lshrrev_b32 v162, 16, v162
    v_add_u32 v163, 2048, v161
    v_mad_u32_u24 v146, v162, s65, v163
    v_add_u32 v162, 699072, v160
    v_lshrrev_b32 v162, 16, v162
    v_add_u32 v163, 3072, v161
    v_mad_u32_u24 v147, v162, s65, v163
    v_add_u32 v162, 932096, v160
    v_lshrrev_b32 v162, 16, v162
    v_add_u32 v163, 4096, v161
    v_mad_u32_u24 v148, v162, s65, v163
    v_add_u32 v162, 1165120, v160
    v_lshrrev_b32 v162, 16, v162
    v_add_u32 v163, 5120, v161
    v_mad_u32_u24 v149, v162, s65, v163
    v_add_u32 v162, 1398144, v160
    v_lshrrev_b32 v162, 16, v162
    v_add_u32 v163, 6144, v161
    v_mad_u32_u24 v150, v162, s65, v163
    v_add_u32 v162, 1631168, v160
    v_lshrrev_b32 v162, 16, v162
    v_add_u32 v163, 7168, v161
    v_mad_u32_u24 v151, v162, s65, v163
    v_add_u32 v162, 1864192, v160
    v_lshrrev_b32 v162, 16, v162
    v_add_u32 v163, 8192, v161
    v_mad_u32_u24 v152, v162, s65, v163
    v_and_b32 v160, 3, v254
    v_min_u32 v160, 2, v160
    s_mov_b32 s65, 2752
    s_mov_b32 s68, 88064
    s_branch LL_C
LL_Q:
    s_mov_b32 s28, s6
    s_mov_b32 s29, s7
    s_mov_b32 s30, 0x180000
    v_lshrrev_b32 v161, 4, v254
    v_mul_u32_u24 v160, 3072, v161
    v_bfe_u32 v162, v254, 2, 2
    v_xor_b32 v162, v162, v161
    v_lshl_add_u32 v160, v162, 6, v160
    v_and_b32 v161, 3, v254
    v_lshl_add_u32 v160, v161, 4, v160
    s_lshl_b32 s64, s21, 9
    s_lshl_b32 s65, s63, 8
    s_add_u32 s64, s64, s65
    v_add_u32 v144, s64, v160
    v_add_u32 v145, 12288, v144
    v_add_u32 v146, 24576, v144
    v_add_u32 v147, 36864, v144
    v_add_u32 v148, 49152, v144
    v_add_u32 v149, 61440, v144
    v_add_u32 v150, 73728, v144
    v_add_u32 v151, 86016, v144
    v_add_u32 v152, 98304, v144
    v_and_b32 v160, 1, v254
    s_mov_b32 s65, 3072
    s_mov_b32 s68, 98304
LL_C:
    s_and_b32 s66, s20, 3
    s_lshl_b32 s66, s66, 3
    v_lshrrev_b32 v161, 2, v254
    v_add_u32 v161, s66, v161
    v_mul_u32_u24 v161, s65, v161
    v_lshl_add_u32 v161, v160, 7, v161
    v_add_u32 v153, s64, v161
    s_mov_b32 s31, 0x00020000
    s_mul_i32 s71, s62, 18560
    s_mul_i32 s66, s63, 9344
    s_add_u32 s71, s71, s66
    s_add_u32 s71, s71, 32768
    s_mov_b32 s72, s71
    s_add_u32 s73, s71, 111360
    s_mul_i32 s74, s62, s68
    s_lshl_b32 s68, s68, 1
    s_add_u32 s87, s80, 2
    s_and_b32 s87, s87, 3
    s_lshl_b32 s89, s87, 13
    s_add_u32 s89, s89, s61
    buffer_load_dwordx4 v[64:67], v212, s[24:27], s89 offen offset:0
    buffer_load_dwordx4 v[68:71], v212, s[24:27], s89 offen offset:128
    buffer_load_dwordx4 v[72:75], v212, s[24:27], s89 offen offset:256
    buffer_load_dwordx4 v[76:79], v212, s[24:27], s89 offen offset:384
    buffer_load_dwordx4 v[80:83], v212, s[24:27], s89 offen offset:512
    buffer_load_dwordx4 v[84:87], v212, s[24:27], s89 offen offset:640
    buffer_load_dwordx4 v[88:91], v212, s[24:27], s89 offen offset:768
    buffer_load_dwordx4 v[92:95], v212, s[24:27], s89 offen offset:896
    s_cmp_lt_u32 s21, 2
    s_cselect_b32 s69, 0x3eb8aa3b, 1.0
    s_lshr_b32 s64, s21, 1
    s_cmp_eq_u32 s64, 2
    s_cselect_b32 s69, 0x4f800000, s69
    v_mov_b32 v216, 0
    v_mov_b32 v217, 0
    v_mov_b32 v218, 0
    v_mov_b32 v219, 0
    v_mov_b32 v220, 0
    v_mov_b32 v221, 0
    v_mov_b32 v222, 0
    v_mov_b32 v223, 0
    s_mov_b32 s78, 0x3f803f80
    v_mov_b32 v249, 0
    v_lshlrev_b32 v244, 1, v254
    s_cmp_ge_u32 s21, 6
    s_cselect_b32 s79, s60, 0
    s_waitcnt vmcnt(16)
    s_add_u32 s88, s80, 3
    s_and_b32 s88, s88, 3
    s_lshl_b32 s89, s88, 13
    s_add_u32 s89, s89, s61
    buffer_load_dwordx4 v[96:99], v212, s[24:27], s89 offen offset:0
    buffer_load_dwordx4 v[100:103], v212, s[24:27], s89 offen offset:128
    buffer_load_dwordx4 v[104:107], v212, s[24:27], s89 offen offset:256
    buffer_load_dwordx4 v[108:111], v212, s[24:27], s89 offen offset:384
    buffer_load_dwordx4 v[112:115], v212, s[24:27], s89 offen offset:512
    buffer_load_dwordx4 v[116:119], v212, s[24:27], s89 offen offset:640
    buffer_load_dwordx4 v[120:123], v212, s[24:27], s89 offen offset:768
    buffer_load_dwordx4 v[124:127], v212, s[24:27], s89 offen offset:896
    v_dot2c_f32_bf16 v220, v0, v0
    v_dot2c_f32_bf16 v216, s78, v0
    v_dot2c_f32_bf16 v220, v1, v1
    v_dot2c_f32_bf16 v216, s78, v1
    v_dot2c_f32_bf16 v220, v2, v2
    v_dot2c_f32_bf16 v216, s78, v2
    v_dot2c_f32_bf16 v220, v3, v3
    v_dot2c_f32_bf16 v216, s78, v3
    v_dot2c_f32_bf16 v220, v4, v4
    v_dot2c_f32_bf16 v216, s78, v4
    v_dot2c_f32_bf16 v220, v5, v5
    v_dot2c_f32_bf16 v216, s78, v5
    v_dot2c_f32_bf16 v220, v6, v6
    v_dot2c_f32_bf16 v216, s78, v6
    v_dot2c_f32_bf16 v220, v7, v7
    v_dot2c_f32_bf16 v216, s78, v7
    v_dot2c_f32_bf16 v220, v8, v8
    v_dot2c_f32_bf16 v216, s78, v8
    v_dot2c_f32_bf16 v220, v9, v9
    v_dot2c_f32_bf16 v216, s78, v9
    v_dot2c_f32_bf16 v220, v10, v10
    v_dot2c_f32_bf16 v216, s78, v10
    v_dot2c_f32_bf16 v220, v11, v11
    v_dot2c_f32_bf16 v216, s78, v11
    v_dot2c_f32_bf16 v220, v12, v12
    v_dot2c_f32_bf16 v216, s78, v12
    v_dot2c_f32_bf16 v220, v13, v13
    v_dot2c_f32_bf16 v216, s78, v13
    v_dot2c_f32_bf16 v220, v14, v14
    v_dot2c_f32_bf16 v216, s78, v14
    v_dot2c_f32_bf16 v220, v15, v15
    v_dot2c_f32_bf16 v216, s78, v15
    v_dot2c_f32_bf16 v220, v16, v16
    v_dot2c_f32_bf16 v216, s78, v16
    v_dot2c_f32_bf16 v220, v17, v17
    v_dot2c_f32_bf16 v216, s78, v17
    v_dot2c_f32_bf16 v220, v18, v18
    v_dot2c_f32_bf16 v216, s78, v18
    v_dot2c_f32_bf16 v220, v19, v19
    v_dot2c_f32_bf16 v216, s78, v19
    v_dot2c_f32_bf16 v220, v20, v20
    v_dot2c_f32_bf16 v216, s78, v20
    v_dot2c_f32_bf16 v220, v21, v21
    v_dot2c_f32_bf16 v216, s78, v21
    v_dot2c_f32_bf16 v220, v22, v22
    v_dot2c_f32_bf16 v216, s78, v22
    v_dot2c_f32_bf16 v220, v23, v23
    v_dot2c_f32_bf16 v216, s78, v23
    v_dot2c_f32_bf16 v220, v24, v24
    v_dot2c_f32_bf16 v216, s78, v24
    v_dot2c_f32_bf16 v220, v25, v25
    v_dot2c_f32_bf16 v216, s78, v25
    v_dot2c_f32_bf16 v220, v26, v26
    v_dot2c_f32_bf16 v216, s78, v26
    v_dot2c_f32_bf16 v220, v27, v27
    v_dot2c_f32_bf16 v216, s78, v27
    v_dot2c_f32_bf16 v220, v28, v28
    v_dot2c_f32_bf16 v216, s78, v28
    v_dot2c_f32_bf16 v220, v29, v29
    v_dot2c_f32_bf16 v216, s78, v29
    v_dot2c_f32_bf16 v220, v30, v30
    v_dot2c_f32_bf16 v216, s78, v30
    v_dot2c_f32_bf16 v220, v31, v31
    v_dot2c_f32_bf16 v216, s78, v31
    v_lshrrev_b32 v234, 4, v254
    v_xor_b32 v234, v234, v233
    v_lshlrev_b32 v235, 7, v232
    s_lshl_b32 s64, s60, 12
    v_add_u32 v235, s64, v235
    v_lshl_add_u32 v235, v234, 4, v235
    s_and_b32 s64, s85, 1
    s_lshl_b32 s64, s64, 6
    s_lshl_b32 s65, s85, 10
    s_or_b32 s64, s64, s65
    v_xor_b32 v240, s64, v235
    s_and_b32 s64, s86, 1
    s_lshl_b32 s64, s64, 6
    s_lshl_b32 s65, s86, 10
    s_or_b32 s64, s64, s65
    v_xor_b32 v241, s64, v235
    s_and_b32 s64, s87, 1
    s_lshl_b32 s64, s64, 6
    s_lshl_b32 s65, s87, 10
    s_or_b32 s64, s64, s65
    v_xor_b32 v242, s64, v235
    s_and_b32 s64, s88, 1
    s_lshl_b32 s64, s64, 6
    s_lshl_b32 s65, s88, 10
    s_or_b32 s64, s64, s65
    v_xor_b32 v243, s64, v235
    s_waitcnt vmcnt(16)
    v_dot2c_f32_bf16 v221, v32, v32
    v_dot2c_f32_bf16 v217, s78, v32
    v_dot2c_f32_bf16 v221, v33, v33
    v_dot2c_f32_bf16 v217, s78, v33
    v_dot2c_f32_bf16 v221, v34, v34
    v_dot2c_f32_bf16 v217, s78, v34
    v_dot2c_f32_bf16 v221, v35, v35
    v_dot2c_f32_bf16 v217, s78, v35
    v_dot2c_f32_bf16 v221, v36, v36
    v_dot2c_f32_bf16 v217, s78, v36
    v_dot2c_f32_bf16 v221, v37, v37
    v_dot2c_f32_bf16 v217, s78, v37
    v_dot2c_f32_bf16 v221, v38, v38
    v_dot2c_f32_bf16 v217, s78, v38
    v_dot2c_f32_bf16 v221, v39, v39
    v_dot2c_f32_bf16 v217, s78, v39
    v_dot2c_f32_bf16 v221, v40, v40
    v_dot2c_f32_bf16 v217, s78, v40
    v_dot2c_f32_bf16 v221, v41, v41
    v_dot2c_f32_bf16 v217, s78, v41
    v_dot2c_f32_bf16 v221, v42, v42
    v_dot2c_f32_bf16 v217, s78, v42
    v_dot2c_f32_bf16 v221, v43, v43
    v_dot2c_f32_bf16 v217, s78, v43
    v_dot2c_f32_bf16 v221, v44, v44
    v_dot2c_f32_bf16 v217, s78, v44
    v_dot2c_f32_bf16 v221, v45, v45
    v_dot2c_f32_bf16 v217, s78, v45
    v_dot2c_f32_bf16 v221, v46, v46
    v_dot2c_f32_bf16 v217, s78, v46
    v_dot2c_f32_bf16 v221, v47, v47
    v_dot2c_f32_bf16 v217, s78, v47
    v_dot2c_f32_bf16 v221, v48, v48
    v_dot2c_f32_bf16 v217, s78, v48
    v_dot2c_f32_bf16 v221, v49, v49
    v_dot2c_f32_bf16 v217, s78, v49
    v_dot2c_f32_bf16 v221, v50, v50
    v_dot2c_f32_bf16 v217, s78, v50
    v_dot2c_f32_bf16 v221, v51, v51
    v_dot2c_f32_bf16 v217, s78, v51
    v_dot2c_f32_bf16 v221, v52, v52
    v_dot2c_f32_bf16 v217, s78, v52
    v_dot2c_f32_bf16 v221, v53, v53
    v_dot2c_f32_bf16 v217, s78, v53
    v_dot2c_f32_bf16 v221, v54, v54
    v_dot2c_f32_bf16 v217, s78, v54
    v_dot2c_f32_bf16 v221, v55, v55
    v_dot2c_f32_bf16 v217, s78, v55
    v_dot2c_f32_bf16 v221, v56, v56
    v_dot2c_f32_bf16 v217, s78, v56
    v_dot2c_f32_bf16 v221, v57, v57
    v_dot2c_f32_bf16 v217, s78, v57
    v_dot2c_f32_bf16 v221, v58, v58
    v_dot2c_f32_bf16 v217, s78, v58
    v_dot2c_f32_bf16 v221, v59, v59
    v_dot2c_f32_bf16 v217, s78, v59
    v_dot2c_f32_bf16 v221, v60, v60
    v_dot2c_f32_bf16 v217, s78, v60
    v_dot2c_f32_bf16 v221, v61, v61
    v_dot2c_f32_bf16 v217, s78, v61
    v_dot2c_f32_bf16 v221, v62, v62
    v_dot2c_f32_bf16 v217, s78, v62
    v_dot2c_f32_bf16 v221, v63, v63
    v_dot2c_f32_bf16 v217, s78, v63
    s_waitcnt vmcnt(8)
    s_add_u32 m0, s72, 0
    s_nop 0
    buffer_load_dwordx4 v144, s[28:31], s74 offen lds
    v_dot2c_f32_bf16 v222, v64, v64
    v_dot2c_f32_bf16 v218, s78, v64
    v_dot2c_f32_bf16 v222, v65, v65
    v_dot2c_f32_bf16 v218, s78, v65
    v_dot2c_f32_bf16 v222, v66, v66
    v_dot2c_f32_bf16 v218, s78, v66
    v_dot2c_f32_bf16 v222, v67, v67
    s_add_u32 m0, s72, 1024
    s_nop 0
    buffer_load_dwordx4 v145, s[28:31], s74 offen lds
    v_dot2c_f32_bf16 v218, s78, v67
    v_dot2c_f32_bf16 v222, v68, v68
    v_dot2c_f32_bf16 v218, s78, v68
    v_dot2c_f32_bf16 v222, v69, v69
    v_dot2c_f32_bf16 v218, s78, v69
    v_dot2c_f32_bf16 v222, v70, v70
    v_dot2c_f32_bf16 v218, s78, v70
    s_add_u32 m0, s72, 2048
    s_nop 0
    buffer_load_dwordx4 v146, s[28:31], s74 offen lds
    v_dot2c_f32_bf16 v222, v71, v71
    v_dot2c_f32_bf16 v218, s78, v71
    v_dot2c_f32_bf16 v222, v72, v72
    v_dot2c_f32_bf16 v218, s78, v72
    v_dot2c_f32_bf16 v222, v73, v73
    v_dot2c_f32_bf16 v218, s78, v73
    v_dot2c_f32_bf16 v222, v74, v74
    s_add_u32 m0, s72, 3072
    s_nop 0
    buffer_load_dwordx4 v147, s[28:31], s74 offen lds
    v_dot2c_f32_bf16 v218, s78, v74
    v_dot2c_f32_bf16 v222, v75, v75
    v_dot2c_f32_bf16 v218, s78, v75
    v_dot2c_f32_bf16 v222, v76, v76
    v_dot2c_f32_bf16 v218, s78, v76
    v_dot2c_f32_bf16 v222, v77, v77
    v_dot2c_f32_bf16 v218, s78, v77
    s_add_u32 m0, s72, 4096
    s_nop 0
    buffer_load_dwordx4 v148, s[28:31], s74 offen lds
    v_dot2c_f32_bf16 v222, v78, v78
    v_dot2c_f32_bf16 v218, s78, v78
    v_dot2c_f32_bf16 v222, v79, v79
    v_dot2c_f32_bf16 v218, s78, v79
    v_dot2c_f32_bf16 v222, v80, v80
    v_dot2c_f32_bf16 v218, s78, v80
    v_dot2c_f32_bf16 v222, v81, v81
    s_add_u32 m0, s72, 5120
    s_nop 0
    buffer_load_dwordx4 v149, s[28:31], s74 offen lds
    v_dot2c_f32_bf16 v218, s78, v81
    v_dot2c_f32_bf16 v222, v82, v82
    v_dot2c_f32_bf16 v218, s78, v82
    v_dot2c_f32_bf16 v222, v83, v83
    v_dot2c_f32_bf16 v218, s78, v83
    v_dot2c_f32_bf16 v222, v84, v84
    v_dot2c_f32_bf16 v218, s78, v84
    s_add_u32 m0, s72, 6144
    s_nop 0
    buffer_load_dwordx4 v150, s[28:31], s74 offen lds
    v_dot2c_f32_bf16 v222, v85, v85
    v_dot2c_f32_bf16 v218, s78, v85
    v_dot2c_f32_bf16 v222, v86, v86
    v_dot2c_f32_bf16 v218, s78, v86
    v_dot2c_f32_bf16 v222, v87, v87
    v_dot2c_f32_bf16 v218, s78, v87
    v_dot2c_f32_bf16 v222, v88, v88
    s_add_u32 m0, s72, 7168
    s_nop 0
    buffer_load_dwordx4 v151, s[28:31], s74 offen lds
    v_dot2c_f32_bf16 v218, s78, v88
    v_dot2c_f32_bf16 v222, v89, v89
    v_dot2c_f32_bf16 v218, s78, v89
    v_dot2c_f32_bf16 v222, v90, v90
    v_dot2c_f32_bf16 v218, s78, v90
    v_dot2c_f32_bf16 v222, v91, v91
    v_dot2c_f32_bf16 v218, s78, v91
    s_cmp_lt_u32 s21, 6
    s_cbranch_scc1 LL_D1
    s_add_u32 m0, s72, 8192
    s_nop 0
    buffer_load_dwordx4 v152, s[28:31], s74 offen lds
LL_D1:
    s_add_u32 s74, s74, s68
    s_add_u32 s72, s72, 37120
    s_cmp_eq_u32 s72, s73
    s_cselect_b32 s72, s71, s72
    v_dot2c_f32_bf16 v222, v92, v92
    v_dot2c_f32_bf16 v218, s78, v92
    v_dot2c_f32_bf16 v222, v93, v93
    v_dot2c_f32_bf16 v218, s78, v93
    v_dot2c_f32_bf16 v222, v94, v94
    v_dot2c_f32_bf16 v218, s78, v94
    v_dot2c_f32_bf16 v222, v95, v95
    v_dot2c_f32_bf16 v218, s78, v95
    s_waitcnt vmcnt(9)
    s_cmp_ge_u32 s21, 6
    s_cbranch_scc1 LL_G3
    s_waitcnt vmcnt(8)
LL_G3:
    v_dot2c_f32_bf16 v223, v96, v96
    v_dot2c_f32_bf16 v219, s78, v96
    v_dot2c_f32_bf16 v223, v97, v97
    v_dot2c_f32_bf16 v219, s78, v97
    v_dot2c_f32_bf16 v223, v98, v98
    v_dot2c_f32_bf16 v219, s78, v98
    v_dot2c_f32_bf16 v223, v99, v99
    v_dot2c_f32_bf16 v219, s78, v99
    v_dot2c_f32_bf16 v223, v100, v100
    v_dot2c_f32_bf16 v219, s78, v100
    v_dot2c_f32_bf16 v223, v101, v101
    v_dot2c_f32_bf16 v219, s78, v101
    v_dot2c_f32_bf16 v223, v102, v102
    v_dot2c_f32_bf16 v219, s78, v102
    v_dot2c_f32_bf16 v223, v103, v103
    v_dot2c_f32_bf16 v219, s78, v103
    v_dot2c_f32_bf16 v223, v104, v104
    v_dot2c_f32_bf16 v219, s78, v104
    v_dot2c_f32_bf16 v223, v105, v105
    v_dot2c_f32_bf16 v219, s78, v105
    v_dot2c_f32_bf16 v223, v106, v106
    v_dot2c_f32_bf16 v219, s78, v106
    v_dot2c_f32_bf16 v223, v107, v107
    v_dot2c_f32_bf16 v219, s78, v107
    v_dot2c_f32_bf16 v223, v108, v108
    v_dot2c_f32_bf16 v219, s78, v108
    v_dot2c_f32_bf16 v223, v109, v109
    v_dot2c_f32_bf16 v219, s78, v109
    v_dot2c_f32_bf16 v223, v110, v110
    v_dot2c_f32_bf16 v219, s78, v110
    v_dot2c_f32_bf16 v223, v111, v111
    v_dot2c_f32_bf16 v219, s78, v111
    v_dot2c_f32_bf16 v223, v112, v112
    v_dot2c_f32_bf16 v219, s78, v112
    v_dot2c_f32_bf16 v223, v113, v113
    v_dot2c_f32_bf16 v219, s78, v113
    v_dot2c_f32_bf16 v223, v114, v114
    v_dot2c_f32_bf16 v219, s78, v114
    v_dot2c_f32_bf16 v223, v115, v115
    v_dot2c_f32_bf16 v219, s78, v115
    v_dot2c_f32_bf16 v223, v116, v116
    v_dot2c_f32_bf16 v219, s78, v116
    v_dot2c_f32_bf16 v223, v117, v117
    v_dot2c_f32_bf16 v219, s78, v117
    v_dot2c_f32_bf16 v223, v118, v118
    v_dot2c_f32_bf16 v219, s78, v118
    v_dot2c_f32_bf16 v223, v119, v119
    v_dot2c_f32_bf16 v219, s78, v119
    v_dot2c_f32_bf16 v223, v120, v120
    v_dot2c_f32_bf16 v219, s78, v120
    v_dot2c_f32_bf16 v223, v121, v121
    v_dot2c_f32_bf16 v219, s78, v121
    v_dot2c_f32_bf16 v223, v122, v122
    v_dot2c_f32_bf16 v219, s78, v122
    v_dot2c_f32_bf16 v223, v123, v123
    v_dot2c_f32_bf16 v219, s78, v123
    v_dot2c_f32_bf16 v223, v124, v124
    v_dot2c_f32_bf16 v219, s78, v124
    v_dot2c_f32_bf16 v223, v125, v125
    v_dot2c_f32_bf16 v219, s78, v125
    v_dot2c_f32_bf16 v223, v126, v126
    v_dot2c_f32_bf16 v219, s78, v126
    v_dot2c_f32_bf16 v223, v127, v127
    v_dot2c_f32_bf16 v219, s78, v127
    s_nop 2
    v_add_f32_dpp v216, v216, v216 quad_perm:[1,0,3,2] row_mask:0xf bank_mask:0xf
    v_add_f32_dpp v217, v217, v217 quad_perm:[1,0,3,2] row_mask:0xf bank_mask:0xf
    v_add_f32_dpp v218, v218, v218 quad_perm:[1,0,3,2] row_mask:0xf bank_mask:0xf
    v_add_f32_dpp v219, v219, v219 quad_perm:[1,0,3,2] row_mask:0xf bank_mask:0xf
    v_add_f32_dpp v220, v220, v220 quad_perm:[1,0,3,2] row_mask:0xf bank_mask:0xf
    v_add_f32_dpp v221, v221, v221 quad_perm:[1,0,3,2] row_mask:0xf bank_mask:0xf
    v_add_f32_dpp v222, v222, v222 quad_perm:[1,0,3,2] row_mask:0xf bank_mask:0xf
    v_add_f32_dpp v223, v223, v223 quad_perm:[1,0,3,2] row_mask:0xf bank_mask:0xf
    v_add_f32_dpp v216, v216, v216 quad_perm:[2,3,0,1] row_mask:0xf bank_mask:0xf
    v_add_f32_dpp v217, v217, v217 quad_perm:[2,3,0,1] row_mask:0xf bank_mask:0xf
    v_add_f32_dpp v218, v218, v218 quad_perm:[2,3,0,1] row_mask:0xf bank_mask:0xf
    v_add_f32_dpp v219, v219, v219 quad_perm:[2,3,0,1] row_mask:0xf bank_mask:0xf
    v_add_f32_dpp v220, v220, v220 quad_perm:[2,3,0,1] row_mask:0xf bank_mask:0xf
    v_add_f32_dpp v221, v221, v221 quad_perm:[2,3,0,1] row_mask:0xf bank_mask:0xf
    v_add_f32_dpp v222, v222, v222 quad_perm:[2,3,0,1] row_mask:0xf bank_mask:0xf
    v_add_f32_dpp v223, v223, v223 quad_perm:[2,3,0,1] row_mask:0xf bank_mask:0xf
    v_add_f32_dpp v216, v216, v216 row_half_mirror row_mask:0xf bank_mask:0xf
    v_add_f32_dpp v217, v217, v217 row_half_mirror row_mask:0xf bank_mask:0xf
    v_add_f32_dpp v218, v218, v218 row_half_mirror row_mask:0xf bank_mask:0xf
    v_add_f32_dpp v219, v219, v219 row_half_mirror row_mask:0xf bank_mask:0xf
    v_add_f32_dpp v220, v220, v220 row_half_mirror row_mask:0xf bank_mask:0xf
    v_add_f32_dpp v221, v221, v221 row_half_mirror row_mask:0xf bank_mask:0xf
    v_add_f32_dpp v222, v222, v222 row_half_mirror row_mask:0xf bank_mask:0xf
    v_add_f32_dpp v223, v223, v223 row_half_mirror row_mask:0xf bank_mask:0xf
    v_mul_f32 v216, 0x3b000000, v216
    v_mul_f32 v217, 0x3b000000, v217
    v_mul_f32 v218, 0x3b000000, v218
    v_mul_f32 v219, 0x3b000000, v219
    v_mul_f32 v220, 0x3b000000, v220
    v_mul_f32 v221, 0x3b000000, v221
    v_mul_f32 v222, 0x3b000000, v222
    v_mul_f32 v223, 0x3b000000, v223
    v_fma_f32 v220, -v216, v216, v220
    v_fma_f32 v221, -v217, v217, v221
    v_fma_f32 v222, -v218, v218, v222
    v_fma_f32 v223, -v219, v219, v223
    v_max_f32 v220, 0, v220
    v_max_f32 v221, 0, v221
    v_max_f32 v222, 0, v222
    v_max_f32 v223, 0, v223
    v_cvt_pk_bf16_f32 v220, v216, v220
    v_cvt_pk_bf16_f32 v221, v217, v221
    v_cvt_pk_bf16_f32 v222, v218, v222
    v_cvt_pk_bf16_f32 v223, v219, v223
    v_lshlrev_b32 v216, 16, v220
    v_lshlrev_b32 v217, 16, v221
    v_lshlrev_b32 v218, 16, v222
    v_lshlrev_b32 v219, 16, v223
    v_and_b32 v220, 0xffff0000, v220
    v_and_b32 v221, 0xffff0000, v221
    v_and_b32 v222, 0xffff0000, v222
    v_and_b32 v223, 0xffff0000, v223
    v_add_f32 v220, 0x3727c5ac, v220
    v_add_f32 v221, 0x3727c5ac, v221
    v_add_f32 v222, 0x3727c5ac, v222
    v_add_f32 v223, 0x3727c5ac, v223
    v_cvt_pk_bf16_f32 v220, v220, v220
    v_cvt_pk_bf16_f32 v221, v221, v221
    v_cvt_pk_bf16_f32 v222, v222, v222
    v_cvt_pk_bf16_f32 v223, v223, v223
    v_and_b32 v220, 0xffff0000, v220
    v_and_b32 v221, 0xffff0000, v221
    v_and_b32 v222, 0xffff0000, v222
    v_and_b32 v223, 0xffff0000, v223
    v_sqrt_f32 v220, v220
    v_sqrt_f32 v221, v221
    v_sqrt_f32 v222, v222
    v_sqrt_f32 v223, v223
    v_cvt_pk_bf16_f32 v220, v220, v220
    v_cvt_pk_bf16_f32 v221, v221, v221
    v_cvt_pk_bf16_f32 v222, v222, v222
    v_cvt_pk_bf16_f32 v223, v223, v223
    v_and_b32 v220, 0xffff0000, v220
    v_and_b32 v221, 0xffff0000, v221
    v_and_b32 v222, 0xffff0000, v222
    v_and_b32 v223, 0xffff0000, v223
    v_rcp_f32 v224, v220
    v_rcp_f32 v225, v221
    v_rcp_f32 v226, v222
    v_rcp_f32 v227, v223
    v_mul_f32 v224, s69, v224
    v_mul_f32 v225, s69, v225
    v_mul_f32 v226, s69, v226
    v_mul_f32 v227, s69, v227
    v_mul_f32 v228, v216, v224
    v_mul_f32 v229, v217, v225
    v_mul_f32 v230, v218, v226
    v_mul_f32 v231, v219, v227
    s_add_u32 m0, s72, 0
    s_nop 0
    buffer_load_dwordx4 v144, s[28:31], s74 offen lds
    v_lshlrev_b32 v232, 16, v0
    v_and_b32 v233, 0xffff0000, v0
    v_lshlrev_b32 v234, 16, v1
    v_and_b32 v235, 0xffff0000, v1
    v_lshlrev_b32 v236, 16, v2
    v_and_b32 v237, 0xffff0000, v2
    v_lshlrev_b32 v238, 16, v3
    v_and_b32 v239, 0xffff0000, v3
    v_fma_f32 v232, v232, v224, -v228
    v_fma_f32 v233, v233, v224, -v228
    v_fma_f32 v234, v234, v224, -v228
    v_fma_f32 v235, v235, v224, -v228
    s_add_u32 m0, s72, 1024
    s_nop 0
    buffer_load_dwordx4 v145, s[28:31], s74 offen lds
    v_fma_f32 v236, v236, v224, -v228
    v_fma_f32 v237, v237, v224, -v228
    v_fma_f32 v238, v238, v224, -v228
    v_fma_f32 v239, v239, v224, -v228
    v_cvt_pk_bf16_f32 v0, v232, v233
    v_cvt_pk_bf16_f32 v1, v234, v235
    v_cvt_pk_bf16_f32 v2, v236, v237
    v_cvt_pk_bf16_f32 v3, v238, v239
    ds_write_b128 v240, v[0:3] offset:0
    v_lshlrev_b32 v232, 16, v32
    v_and_b32 v233, 0xffff0000, v32
    v_lshlrev_b32 v234, 16, v33
    s_add_u32 m0, s72, 2048
    s_nop 0
    buffer_load_dwordx4 v146, s[28:31], s74 offen lds
    v_and_b32 v235, 0xffff0000, v33
    v_lshlrev_b32 v236, 16, v34
    v_and_b32 v237, 0xffff0000, v34
    v_lshlrev_b32 v238, 16, v35
    v_and_b32 v239, 0xffff0000, v35
    v_fma_f32 v232, v232, v225, -v229
    v_fma_f32 v233, v233, v225, -v229
    v_fma_f32 v234, v234, v225, -v229
    v_fma_f32 v235, v235, v225, -v229
    v_fma_f32 v236, v236, v225, -v229
    v_fma_f32 v237, v237, v225, -v229
    v_fma_f32 v238, v238, v225, -v229
    s_add_u32 m0, s72, 3072
    s_nop 0
    buffer_load_dwordx4 v147, s[28:31], s74 offen lds
    v_fma_f32 v239, v239, v225, -v229
    v_cvt_pk_bf16_f32 v32, v232, v233
    v_cvt_pk_bf16_f32 v33, v234, v235
    v_cvt_pk_bf16_f32 v34, v236, v237
    v_cvt_pk_bf16_f32 v35, v238, v239
    ds_write_b128 v241, v[32:35] offset:0
    v_lshlrev_b32 v232, 16, v64
    v_and_b32 v233, 0xffff0000, v64
    v_lshlrev_b32 v234, 16, v65
    v_and_b32 v235, 0xffff0000, v65
    v_lshlrev_b32 v236, 16, v66
    v_and_b32 v237, 0xffff0000, v66
    s_add_u32 m0, s72, 4096
    s_nop 0
    buffer_load_dwordx4 v148, s[28:31], s74 offen lds
    v_lshlrev_b32 v238, 16, v67
    v_and_b32 v239, 0xffff0000, v67
    v_fma_f32 v232, v232, v226, -v230
    v_fma_f32 v233, v233, v226, -v230
    v_fma_f32 v234, v234, v226, -v230
    v_fma_f32 v235, v235, v226, -v230
    v_fma_f32 v236, v236, v226, -v230
    v_fma_f32 v237, v237, v226, -v230
    v_fma_f32 v238, v238, v226, -v230
    v_fma_f32 v239, v239, v226, -v230
    v_cvt_pk_bf16_f32 v64, v232, v233
    v_cvt_pk_bf16_f32 v65, v234, v235
    s_add_u32 m0, s72, 5120
    s_nop 0
    buffer_load_dwordx4 v149, s[28:31], s74 offen lds
    v_cvt_pk_bf16_f32 v66, v236, v237
    v_cvt_pk_bf16_f32 v67, v238, v239
    ds_write_b128 v242, v[64:67] offset:0
    v_lshlrev_b32 v232, 16, v96
    v_and_b32 v233, 0xffff0000, v96
    v_lshlrev_b32 v234, 16, v97
    v_and_b32 v235, 0xffff0000, v97
    v_lshlrev_b32 v236, 16, v98
    v_and_b32 v237, 0xffff0000, v98
    v_lshlrev_b32 v238, 16, v99
    v_and_b32 v239, 0xffff0000, v99
    v_fma_f32 v232, v232, v227, -v231
    s_add_u32 m0, s72, 6144
    s_nop 0
    buffer_load_dwordx4 v150, s[28:31], s74 offen lds
    v_fma_f32 v233, v233, v227, -v231
    v_fma_f32 v234, v234, v227, -v231
    v_fma_f32 v235, v235, v227, -v231
    v_fma_f32 v236, v236, v227, -v231
    v_fma_f32 v237, v237, v227, -v231
    v_fma_f32 v238, v238, v227, -v231
    v_fma_f32 v239, v239, v227, -v231
    v_cvt_pk_bf16_f32 v96, v232, v233
    v_cvt_pk_bf16_f32 v97, v234, v235
    v_cvt_pk_bf16_f32 v98, v236, v237
    v_cvt_pk_bf16_f32 v99, v238, v239
    ds_write_b128 v243, v[96:99] offset:0
    s_add_u32 m0, s72, 7168
    s_nop 0
    buffer_load_dwordx4 v151, s[28:31], s74 offen lds
    s_cmp_lt_u32 s21, 6
    s_cbranch_scc1 LL_D2
    s_add_u32 m0, s72, 8192
    s_nop 0
    buffer_load_dwordx4 v152, s[28:31], s74 offen lds
LL_D2:
    s_add_u32 s74, s74, s68
    s_add_u32 s72, s72, 37120
    s_cmp_eq_u32 s72, s73
    s_cselect_b32 s72, s71, s72
    s_waitcnt vmcnt(8) lgkmcnt(0)
    s_barrier
    s_add_u32 m0, s72, 0
    s_nop 0
    buffer_load_dwordx4 v144, s[28:31], s74 offen lds
    v_lshlrev_b32 v232, 16, v4
    v_and_b32 v233, 0xffff0000, v4
    v_lshlrev_b32 v234, 16, v5
    v_and_b32 v235, 0xffff0000, v5
    v_lshlrev_b32 v236, 16, v6
    v_and_b32 v237, 0xffff0000, v6
    v_lshlrev_b32 v238, 16, v7
    v_and_b32 v239, 0xffff0000, v7
    v_fma_f32 v232, v232, v224, -v228
    v_fma_f32 v233, v233, v224, -v228
    v_fma_f32 v234, v234, v224, -v228
    v_fma_f32 v235, v235, v224, -v228
    s_add_u32 m0, s72, 1024
    s_nop 0
    buffer_load_dwordx4 v145, s[28:31], s74 offen lds
    v_fma_f32 v236, v236, v224, -v228
    v_fma_f32 v237, v237, v224, -v228
    v_fma_f32 v238, v238, v224, -v228
    v_fma_f32 v239, v239, v224, -v228
    v_cvt_pk_bf16_f32 v4, v232, v233
    v_cvt_pk_bf16_f32 v5, v234, v235
    v_cvt_pk_bf16_f32 v6, v236, v237
    v_cvt_pk_bf16_f32 v7, v238, v239
    ds_write_b128 v240, v[4:7] offset:16384
    v_lshlrev_b32 v232, 16, v36
    v_and_b32 v233, 0xffff0000, v36
    v_lshlrev_b32 v234, 16, v37
    s_add_u32 m0, s72, 2048
    s_nop 0
    buffer_load_dwordx4 v146, s[28:31], s74 offen lds
    v_and_b32 v235, 0xffff0000, v37
    v_lshlrev_b32 v236, 16, v38
    v_and_b32 v237, 0xffff0000, v38
    v_lshlrev_b32 v238, 16, v39
    v_and_b32 v239, 0xffff0000, v39
    v_fma_f32 v232, v232, v225, -v229
    v_fma_f32 v233, v233, v225, -v229
    v_fma_f32 v234, v234, v225, -v229
    v_fma_f32 v235, v235, v225, -v229
    v_fma_f32 v236, v236, v225, -v229
    v_fma_f32 v237, v237, v225, -v229
    v_fma_f32 v238, v238, v225, -v229
    s_add_u32 m0, s72, 3072
    s_nop 0
    buffer_load_dwordx4 v147, s[28:31], s74 offen lds
    v_fma_f32 v239, v239, v225, -v229
    v_cvt_pk_bf16_f32 v36, v232, v233
    v_cvt_pk_bf16_f32 v37, v234, v235
    v_cvt_pk_bf16_f32 v38, v236, v237
    v_cvt_pk_bf16_f32 v39, v238, v239
    ds_write_b128 v241, v[36:39] offset:16384
    v_lshlrev_b32 v232, 16, v68
    v_and_b32 v233, 0xffff0000, v68
    v_lshlrev_b32 v234, 16, v69
    v_and_b32 v235, 0xffff0000, v69
    v_lshlrev_b32 v236, 16, v70
    v_and_b32 v237, 0xffff0000, v70
    s_add_u32 m0, s72, 4096
    s_nop 0
    buffer_load_dwordx4 v148, s[28:31], s74 offen lds
    v_lshlrev_b32 v238, 16, v71
    v_and_b32 v239, 0xffff0000, v71
    v_fma_f32 v232, v232, v226, -v230
    v_fma_f32 v233, v233, v226, -v230
    v_fma_f32 v234, v234, v226, -v230
    v_fma_f32 v235, v235, v226, -v230
    v_fma_f32 v236, v236, v226, -v230
    v_fma_f32 v237, v237, v226, -v230
    v_fma_f32 v238, v238, v226, -v230
    v_fma_f32 v239, v239, v226, -v230
    v_cvt_pk_bf16_f32 v68, v232, v233
    v_cvt_pk_bf16_f32 v69, v234, v235
    s_add_u32 m0, s72, 5120
    s_nop 0
    buffer_load_dwordx4 v149, s[28:31], s74 offen lds
    v_cvt_pk_bf16_f32 v70, v236, v237
    v_cvt_pk_bf16_f32 v71, v238, v239
    ds_write_b128 v242, v[68:71] offset:16384
    v_lshlrev_b32 v232, 16, v100
    v_and_b32 v233, 0xffff0000, v100
    v_lshlrev_b32 v234, 16, v101
    v_and_b32 v235, 0xffff0000, v101
    v_lshlrev_b32 v236, 16, v102
    v_and_b32 v237, 0xffff0000, v102
    v_lshlrev_b32 v238, 16, v103
    v_and_b32 v239, 0xffff0000, v103
    v_fma_f32 v232, v232, v227, -v231
    s_add_u32 m0, s72, 6144
    s_nop 0
    buffer_load_dwordx4 v150, s[28:31], s74 offen lds
    v_fma_f32 v233, v233, v227, -v231
    v_fma_f32 v234, v234, v227, -v231
    v_fma_f32 v235, v235, v227, -v231
    v_fma_f32 v236, v236, v227, -v231
    v_fma_f32 v237, v237, v227, -v231
    v_fma_f32 v238, v238, v227, -v231
    v_fma_f32 v239, v239, v227, -v231
    v_cvt_pk_bf16_f32 v100, v232, v233
    v_cvt_pk_bf16_f32 v101, v234, v235
    v_cvt_pk_bf16_f32 v102, v236, v237
    v_cvt_pk_bf16_f32 v103, v238, v239
    ds_write_b128 v243, v[100:103] offset:16384
    s_add_u32 m0, s72, 7168
    s_nop 0
    buffer_load_dwordx4 v151, s[28:31], s74 offen lds
    s_cmp_lt_u32 s21, 6
    s_cbranch_scc1 LL_D3
    s_add_u32 m0, s72, 8192
    s_nop 0
    buffer_load_dwordx4 v152, s[28:31], s74 offen lds
LL_D3:
    s_add_u32 s74, s74, s68
    s_add_u32 s72, s72, 37120
    s_cmp_eq_u32 s72, s73
    s_cselect_b32 s72, s71, s72
    s_waitcnt vmcnt(8) lgkmcnt(0)
    s_barrier
    s_add_u32 m0, s72, 0
    s_nop 0
    buffer_load_dwordx4 v144, s[28:31], s74 offen lds
    v_lshlrev_b32 v232, 16, v8
    v_and_b32 v233, 0xffff0000, v8
    v_lshlrev_b32 v234, 16, v9
    v_and_b32 v235, 0xffff0000, v9
    v_lshlrev_b32 v236, 16, v10
    v_and_b32 v237, 0xffff0000, v10
    v_lshlrev_b32 v238, 16, v11
    v_and_b32 v239, 0xffff0000, v11
    v_fma_f32 v232, v232, v224, -v228
    v_fma_f32 v233, v233, v224, -v228
    v_fma_f32 v234, v234, v224, -v228
    v_fma_f32 v235, v235, v224, -v228
    s_add_u32 m0, s72, 1024
    s_nop 0
    buffer_load_dwordx4 v145, s[28:31], s74 offen lds
    v_fma_f32 v236, v236, v224, -v228
    v_fma_f32 v237, v237, v224, -v228
    v_fma_f32 v238, v238, v224, -v228
    v_fma_f32 v239, v239, v224, -v228
    v_cvt_pk_bf16_f32 v8, v232, v233
    v_cvt_pk_bf16_f32 v9, v234, v235
    v_cvt_pk_bf16_f32 v10, v236, v237
    v_cvt_pk_bf16_f32 v11, v238, v239
    ds_write_b128 v240, v[8:11] offset:0
    v_lshlrev_b32 v232, 16, v40
    v_and_b32 v233, 0xffff0000, v40
    v_lshlrev_b32 v234, 16, v41
    s_add_u32 m0, s72, 2048
    s_nop 0
    buffer_load_dwordx4 v146, s[28:31], s74 offen lds
    v_and_b32 v235, 0xffff0000, v41
    v_lshlrev_b32 v236, 16, v42
    v_and_b32 v237, 0xffff0000, v42
    v_lshlrev_b32 v238, 16, v43
    v_and_b32 v239, 0xffff0000, v43
    v_fma_f32 v232, v232, v225, -v229
    v_fma_f32 v233, v233, v225, -v229
    v_fma_f32 v234, v234, v225, -v229
    v_fma_f32 v235, v235, v225, -v229
    v_fma_f32 v236, v236, v225, -v229
    v_fma_f32 v237, v237, v225, -v229
    v_fma_f32 v238, v238, v225, -v229
    s_add_u32 m0, s72, 3072
    s_nop 0
    buffer_load_dwordx4 v147, s[28:31], s74 offen lds
    v_fma_f32 v239, v239, v225, -v229
    v_cvt_pk_bf16_f32 v40, v232, v233
    v_cvt_pk_bf16_f32 v41, v234, v235
    v_cvt_pk_bf16_f32 v42, v236, v237
    v_cvt_pk_bf16_f32 v43, v238, v239
    ds_write_b128 v241, v[40:43] offset:0
    v_lshlrev_b32 v232, 16, v72
    v_and_b32 v233, 0xffff0000, v72
    v_lshlrev_b32 v234, 16, v73
    v_and_b32 v235, 0xffff0000, v73
    v_lshlrev_b32 v236, 16, v74
    v_and_b32 v237, 0xffff0000, v74
    s_add_u32 m0, s72, 4096
    s_nop 0
    buffer_load_dwordx4 v148, s[28:31], s74 offen lds
    v_lshlrev_b32 v238, 16, v75
    v_and_b32 v239, 0xffff0000, v75
    v_fma_f32 v232, v232, v226, -v230
    v_fma_f32 v233, v233, v226, -v230
    v_fma_f32 v234, v234, v226, -v230
    v_fma_f32 v235, v235, v226, -v230
    v_fma_f32 v236, v236, v226, -v230
    v_fma_f32 v237, v237, v226, -v230
    v_fma_f32 v238, v238, v226, -v230
    v_fma_f32 v239, v239, v226, -v230
    v_cvt_pk_bf16_f32 v72, v232, v233
    v_cvt_pk_bf16_f32 v73, v234, v235
    s_add_u32 m0, s72, 5120
    s_nop 0
    buffer_load_dwordx4 v149, s[28:31], s74 offen lds
    v_cvt_pk_bf16_f32 v74, v236, v237
    v_cvt_pk_bf16_f32 v75, v238, v239
    ds_write_b128 v242, v[72:75] offset:0
    v_lshlrev_b32 v232, 16, v104
    v_and_b32 v233, 0xffff0000, v104
    v_lshlrev_b32 v234, 16, v105
    v_and_b32 v235, 0xffff0000, v105
    v_lshlrev_b32 v236, 16, v106
    v_and_b32 v237, 0xffff0000, v106
    v_lshlrev_b32 v238, 16, v107
    v_and_b32 v239, 0xffff0000, v107
    v_fma_f32 v232, v232, v227, -v231
    s_add_u32 m0, s72, 6144
    s_nop 0
    buffer_load_dwordx4 v150, s[28:31], s74 offen lds
    v_fma_f32 v233, v233, v227, -v231
    v_fma_f32 v234, v234, v227, -v231
    v_fma_f32 v235, v235, v227, -v231
    v_fma_f32 v236, v236, v227, -v231
    v_fma_f32 v237, v237, v227, -v231
    v_fma_f32 v238, v238, v227, -v231
    v_fma_f32 v239, v239, v227, -v231
    v_cvt_pk_bf16_f32 v104, v232, v233
    v_cvt_pk_bf16_f32 v105, v234, v235
    v_cvt_pk_bf16_f32 v106, v236, v237
    v_cvt_pk_bf16_f32 v107, v238, v239
    ds_write_b128 v243, v[104:107] offset:0
    s_add_u32 m0, s72, 7168
    s_nop 0
    buffer_load_dwordx4 v151, s[28:31], s74 offen lds
    s_cmp_lt_u32 s21, 6
    s_cbranch_scc1 LL_D4
    s_add_u32 m0, s72, 8192
    s_nop 0
    buffer_load_dwordx4 v152, s[28:31], s74 offen lds
LL_D4:
    s_add_u32 s74, s74, s68
    s_add_u32 s72, s72, 37120
    s_cmp_eq_u32 s72, s73
    s_cselect_b32 s72, s71, s72
    s_waitcnt vmcnt(8) lgkmcnt(0)
    s_barrier
    s_add_u32 m0, s72, 0
    s_nop 0
    buffer_load_dwordx4 v144, s[28:31], s74 offen lds
    v_lshlrev_b32 v232, 16, v12
    v_and_b32 v233, 0xffff0000, v12
    v_lshlrev_b32 v234, 16, v13
    v_and_b32 v235, 0xffff0000, v13
    v_lshlrev_b32 v236, 16, v14
    v_and_b32 v237, 0xffff0000, v14
    v_lshlrev_b32 v238, 16, v15
    v_and_b32 v239, 0xffff0000, v15
    v_fma_f32 v232, v232, v224, -v228
    v_fma_f32 v233, v233, v224, -v228
    v_fma_f32 v234, v234, v224, -v228
    v_fma_f32 v235, v235, v224, -v228
    s_add_u32 m0, s72, 1024
    s_nop 0
    buffer_load_dwordx4 v145, s[28:31], s74 offen lds
    v_fma_f32 v236, v236, v224, -v228
    v_fma_f32 v237, v237, v224, -v228
    v_fma_f32 v238, v238, v224, -v228
    v_fma_f32 v239, v239, v224, -v228
    v_cvt_pk_bf16_f32 v12, v232, v233
    v_cvt_pk_bf16_f32 v13, v234, v235
    v_cvt_pk_bf16_f32 v14, v236, v237
    v_cvt_pk_bf16_f32 v15, v238, v239
    ds_write_b128 v240, v[12:15] offset:16384
    v_lshlrev_b32 v232, 16, v44
    v_and_b32 v233, 0xffff0000, v44
    v_lshlrev_b32 v234, 16, v45
    s_add_u32 m0, s72, 2048
    s_nop 0
    buffer_load_dwordx4 v146, s[28:31], s74 offen lds
    v_and_b32 v235, 0xffff0000, v45
    v_lshlrev_b32 v236, 16, v46
    v_and_b32 v237, 0xffff0000, v46
    v_lshlrev_b32 v238, 16, v47
    v_and_b32 v239, 0xffff0000, v47
    v_fma_f32 v232, v232, v225, -v229
    v_fma_f32 v233, v233, v225, -v229
    v_fma_f32 v234, v234, v225, -v229
    v_fma_f32 v235, v235, v225, -v229
    v_fma_f32 v236, v236, v225, -v229
    v_fma_f32 v237, v237, v225, -v229
    v_fma_f32 v238, v238, v225, -v229
    s_add_u32 m0, s72, 3072
    s_nop 0
    buffer_load_dwordx4 v147, s[28:31], s74 offen lds
    v_fma_f32 v239, v239, v225, -v229
    v_cvt_pk_bf16_f32 v44, v232, v233
    v_cvt_pk_bf16_f32 v45, v234, v235
    v_cvt_pk_bf16_f32 v46, v236, v237
    v_cvt_pk_bf16_f32 v47, v238, v239
    ds_write_b128 v241, v[44:47] offset:16384
    v_lshlrev_b32 v232, 16, v76
    v_and_b32 v233, 0xffff0000, v76
    v_lshlrev_b32 v234, 16, v77
    v_and_b32 v235, 0xffff0000, v77
    v_lshlrev_b32 v236, 16, v78
    v_and_b32 v237, 0xffff0000, v78
    s_add_u32 m0, s72, 4096
    s_nop 0
    buffer_load_dwordx4 v148, s[28:31], s74 offen lds
    v_lshlrev_b32 v238, 16, v79
    v_and_b32 v239, 0xffff0000, v79
    v_fma_f32 v232, v232, v226, -v230
    v_fma_f32 v233, v233, v226, -v230
    v_fma_f32 v234, v234, v226, -v230
    v_fma_f32 v235, v235, v226, -v230
    v_fma_f32 v236, v236, v226, -v230
    v_fma_f32 v237, v237, v226, -v230
    v_fma_f32 v238, v238, v226, -v230
    v_fma_f32 v239, v239, v226, -v230
    v_cvt_pk_bf16_f32 v76, v232, v233
    v_cvt_pk_bf16_f32 v77, v234, v235
    s_add_u32 m0, s72, 5120
    s_nop 0
    buffer_load_dwordx4 v149, s[28:31], s74 offen lds
    v_cvt_pk_bf16_f32 v78, v236, v237
    v_cvt_pk_bf16_f32 v79, v238, v239
    ds_write_b128 v242, v[76:79] offset:16384
    v_lshlrev_b32 v232, 16, v108
    v_and_b32 v233, 0xffff0000, v108
    v_lshlrev_b32 v234, 16, v109
    v_and_b32 v235, 0xffff0000, v109
    v_lshlrev_b32 v236, 16, v110
    v_and_b32 v237, 0xffff0000, v110
    v_lshlrev_b32 v238, 16, v111
    v_and_b32 v239, 0xffff0000, v111
    v_fma_f32 v232, v232, v227, -v231
    s_add_u32 m0, s72, 6144
    s_nop 0
    buffer_load_dwordx4 v150, s[28:31], s74 offen lds
    v_fma_f32 v233, v233, v227, -v231
    v_fma_f32 v234, v234, v227, -v231
    v_fma_f32 v235, v235, v227, -v231
    v_fma_f32 v236, v236, v227, -v231
    v_fma_f32 v237, v237, v227, -v231
    v_fma_f32 v238, v238, v227, -v231
    v_fma_f32 v239, v239, v227, -v231
    v_cvt_pk_bf16_f32 v108, v232, v233
    v_cvt_pk_bf16_f32 v109, v234, v235
    v_cvt_pk_bf16_f32 v110, v236, v237
    v_cvt_pk_bf16_f32 v111, v238, v239
    ds_write_b128 v243, v[108:111] offset:16384
    s_add_u32 m0, s72, 7168
    s_nop 0
    buffer_load_dwordx4 v151, s[28:31], s74 offen lds
    s_cmp_lt_u32 s21, 6
    s_cbranch_scc1 LL_D5
    s_add_u32 m0, s72, 8192
    s_nop 0
    buffer_load_dwordx4 v152, s[28:31], s74 offen lds
LL_D5:
    s_add_u32 s74, s74, s68
    s_add_u32 s72, s72, 37120
    s_cmp_eq_u32 s72, s73
    s_cselect_b32 s72, s71, s72
    s_waitcnt vmcnt(8) lgkmcnt(0)
    s_barrier
    s_add_u32 m0, s72, 0
    s_nop 0
    buffer_load_dwordx4 v144, s[28:31], s74 offen lds
    v_lshlrev_b32 v232, 16, v16
    v_and_b32 v233, 0xffff0000, v16
    v_lshlrev_b32 v234, 16, v17
    v_and_b32 v235, 0xffff0000, v17
    v_lshlrev_b32 v236, 16, v18
    v_and_b32 v237, 0xffff0000, v18
    v_lshlrev_b32 v238, 16, v19
    v_and_b32 v239, 0xffff0000, v19
    v_fma_f32 v232, v232, v224, -v228
    v_fma_f32 v233, v233, v224, -v228
    v_fma_f32 v234, v234, v224, -v228
    v_fma_f32 v235, v235, v224, -v228
    s_add_u32 m0, s72, 1024
    s_nop 0
    buffer_load_dwordx4 v145, s[28:31], s74 offen lds
    v_fma_f32 v236, v236, v224, -v228
    v_fma_f32 v237, v237, v224, -v228
    v_fma_f32 v238, v238, v224, -v228
    v_fma_f32 v239, v239, v224, -v228
    v_cvt_pk_bf16_f32 v16, v232, v233
    v_cvt_pk_bf16_f32 v17, v234, v235
    v_cvt_pk_bf16_f32 v18, v236, v237
    v_cvt_pk_bf16_f32 v19, v238, v239
    ds_write_b128 v240, v[16:19] offset:0
    v_lshlrev_b32 v232, 16, v48
    v_and_b32 v233, 0xffff0000, v48
    v_lshlrev_b32 v234, 16, v49
    s_add_u32 m0, s72, 2048
    s_nop 0
    buffer_load_dwordx4 v146, s[28:31], s74 offen lds
    v_and_b32 v235, 0xffff0000, v49
    v_lshlrev_b32 v236, 16, v50
    v_and_b32 v237, 0xffff0000, v50
    v_lshlrev_b32 v238, 16, v51
    v_and_b32 v239, 0xffff0000, v51
    v_fma_f32 v232, v232, v225, -v229
    v_fma_f32 v233, v233, v225, -v229
    v_fma_f32 v234, v234, v225, -v229
    v_fma_f32 v235, v235, v225, -v229
    v_fma_f32 v236, v236, v225, -v229
    v_fma_f32 v237, v237, v225, -v229
    v_fma_f32 v238, v238, v225, -v229
    s_add_u32 m0, s72, 3072
    s_nop 0
    buffer_load_dwordx4 v147, s[28:31], s74 offen lds
    v_fma_f32 v239, v239, v225, -v229
    v_cvt_pk_bf16_f32 v48, v232, v233
    v_cvt_pk_bf16_f32 v49, v234, v235
    v_cvt_pk_bf16_f32 v50, v236, v237
    v_cvt_pk_bf16_f32 v51, v238, v239
    ds_write_b128 v241, v[48:51] offset:0
    v_lshlrev_b32 v232, 16, v80
    v_and_b32 v233, 0xffff0000, v80
    v_lshlrev_b32 v234, 16, v81
    v_and_b32 v235, 0xffff0000, v81
    v_lshlrev_b32 v236, 16, v82
    v_and_b32 v237, 0xffff0000, v82
    s_add_u32 m0, s72, 4096
    s_nop 0
    buffer_load_dwordx4 v148, s[28:31], s74 offen lds
    v_lshlrev_b32 v238, 16, v83
    v_and_b32 v239, 0xffff0000, v83
    v_fma_f32 v232, v232, v226, -v230
    v_fma_f32 v233, v233, v226, -v230
    v_fma_f32 v234, v234, v226, -v230
    v_fma_f32 v235, v235, v226, -v230
    v_fma_f32 v236, v236, v226, -v230
    v_fma_f32 v237, v237, v226, -v230
    v_fma_f32 v238, v238, v226, -v230
    v_fma_f32 v239, v239, v226, -v230
    v_cvt_pk_bf16_f32 v80, v232, v233
    v_cvt_pk_bf16_f32 v81, v234, v235
    s_add_u32 m0, s72, 5120
    s_nop 0
    buffer_load_dwordx4 v149, s[28:31], s74 offen lds
    v_cvt_pk_bf16_f32 v82, v236, v237
    v_cvt_pk_bf16_f32 v83, v238, v239
    ds_write_b128 v242, v[80:83] offset:0
    v_lshlrev_b32 v232, 16, v112
    v_and_b32 v233, 0xffff0000, v112
    v_lshlrev_b32 v234, 16, v113
    v_and_b32 v235, 0xffff0000, v113
    v_lshlrev_b32 v236, 16, v114
    v_and_b32 v237, 0xffff0000, v114
    v_lshlrev_b32 v238, 16, v115
    v_and_b32 v239, 0xffff0000, v115
    v_fma_f32 v232, v232, v227, -v231
    s_add_u32 m0, s72, 6144
    s_nop 0
    buffer_load_dwordx4 v150, s[28:31], s74 offen lds
    v_fma_f32 v233, v233, v227, -v231
    v_fma_f32 v234, v234, v227, -v231
    v_fma_f32 v235, v235, v227, -v231
    v_fma_f32 v236, v236, v227, -v231
    v_fma_f32 v237, v237, v227, -v231
    v_fma_f32 v238, v238, v227, -v231
    v_fma_f32 v239, v239, v227, -v231
    v_cvt_pk_bf16_f32 v112, v232, v233
    v_cvt_pk_bf16_f32 v113, v234, v235
    v_cvt_pk_bf16_f32 v114, v236, v237
    v_cvt_pk_bf16_f32 v115, v238, v239
    ds_write_b128 v243, v[112:115] offset:0
    s_add_u32 m0, s72, 7168
    s_nop 0
    buffer_load_dwordx4 v151, s[28:31], s74 offen lds
    s_cmp_lt_u32 s21, 6
    s_cbranch_scc1 LL_D6
    s_add_u32 m0, s72, 8192
    s_nop 0
    buffer_load_dwordx4 v152, s[28:31], s74 offen lds
LL_D6:
    s_add_u32 s74, s74, s68
    s_add_u32 s72, s72, 37120
    s_cmp_eq_u32 s72, s73
    s_cselect_b32 s72, s71, s72
    v_min_u32 v96, 1, v254
    v_lshlrev_b32 v96, 2, v96
    buffer_load_dword v97, v96, s[36:39], 0 offen sc1
    s_waitcnt vmcnt(8) lgkmcnt(0)
    s_barrier
    s_add_u32 m0, s72, 0
    s_nop 0
    buffer_load_dwordx4 v144, s[28:31], s74 offen lds
    v_lshlrev_b32 v232, 16, v20
    v_and_b32 v233, 0xffff0000, v20
    v_lshlrev_b32 v234, 16, v21
    v_and_b32 v235, 0xffff0000, v21
    v_lshlrev_b32 v236, 16, v22
    v_and_b32 v237, 0xffff0000, v22
    v_lshlrev_b32 v238, 16, v23
    v_and_b32 v239, 0xffff0000, v23
    v_fma_f32 v232, v232, v224, -v228
    v_fma_f32 v233, v233, v224, -v228
    v_fma_f32 v234, v234, v224, -v228
    v_fma_f32 v235, v235, v224, -v228
    s_add_u32 m0, s72, 1024
    s_nop 0
    buffer_load_dwordx4 v145, s[28:31], s74 offen lds
    v_fma_f32 v236, v236, v224, -v228
    v_fma_f32 v237, v237, v224, -v228
    v_fma_f32 v238, v238, v224, -v228
    v_fma_f32 v239, v239, v224, -v228
    v_cvt_pk_bf16_f32 v20, v232, v233
    v_cvt_pk_bf16_f32 v21, v234, v235
    v_cvt_pk_bf16_f32 v22, v236, v237
    v_cvt_pk_bf16_f32 v23, v238, v239
    ds_write_b128 v240, v[20:23] offset:16384
    v_lshlrev_b32 v232, 16, v52
    v_and_b32 v233, 0xffff0000, v52
    v_lshlrev_b32 v234, 16, v53
    s_add_u32 m0, s72, 2048
    s_nop 0
    buffer_load_dwordx4 v146, s[28:31], s74 offen lds
    v_and_b32 v235, 0xffff0000, v53
    v_lshlrev_b32 v236, 16, v54
    v_and_b32 v237, 0xffff0000, v54
    v_lshlrev_b32 v238, 16, v55
    v_and_b32 v239, 0xffff0000, v55
    v_fma_f32 v232, v232, v225, -v229
    v_fma_f32 v233, v233, v225, -v229
    v_fma_f32 v234, v234, v225, -v229
    v_fma_f32 v235, v235, v225, -v229
    v_fma_f32 v236, v236, v225, -v229
    v_fma_f32 v237, v237, v225, -v229
    v_fma_f32 v238, v238, v225, -v229
    s_add_u32 m0, s72, 3072
    s_nop 0
    buffer_load_dwordx4 v147, s[28:31], s74 offen lds
    v_fma_f32 v239, v239, v225, -v229
    v_cvt_pk_bf16_f32 v52, v232, v233
    v_cvt_pk_bf16_f32 v53, v234, v235
    v_cvt_pk_bf16_f32 v54, v236, v237
    v_cvt_pk_bf16_f32 v55, v238, v239
    ds_write_b128 v241, v[52:55] offset:16384
    v_lshlrev_b32 v232, 16, v84
    v_and_b32 v233, 0xffff0000, v84
    v_lshlrev_b32 v234, 16, v85
    v_and_b32 v235, 0xffff0000, v85
    v_lshlrev_b32 v236, 16, v86
    v_and_b32 v237, 0xffff0000, v86
    s_add_u32 m0, s72, 4096
    s_nop 0
    buffer_load_dwordx4 v148, s[28:31], s74 offen lds
    v_lshlrev_b32 v238, 16, v87
    v_and_b32 v239, 0xffff0000, v87
    v_fma_f32 v232, v232, v226, -v230
    v_fma_f32 v233, v233, v226, -v230
    v_fma_f32 v234, v234, v226, -v230
    v_fma_f32 v235, v235, v226, -v230
    v_fma_f32 v236, v236, v226, -v230
    v_fma_f32 v237, v237, v226, -v230
    v_fma_f32 v238, v238, v226, -v230
    v_fma_f32 v239, v239, v226, -v230
    v_cvt_pk_bf16_f32 v84, v232, v233
    v_cvt_pk_bf16_f32 v85, v234, v235
    s_add_u32 m0, s72, 5120
    s_nop 0
    buffer_load_dwordx4 v149, s[28:31], s74 offen lds
    v_cvt_pk_bf16_f32 v86, v236, v237
    v_cvt_pk_bf16_f32 v87, v238, v239
    ds_write_b128 v242, v[84:87] offset:16384
    v_lshlrev_b32 v232, 16, v116
    v_and_b32 v233, 0xffff0000, v116
    v_lshlrev_b32 v234, 16, v117
    v_and_b32 v235, 0xffff0000, v117
    v_lshlrev_b32 v236, 16, v118
    v_and_b32 v237, 0xffff0000, v118
    v_lshlrev_b32 v238, 16, v119
    v_and_b32 v239, 0xffff0000, v119
    v_fma_f32 v232, v232, v227, -v231
    s_add_u32 m0, s72, 6144
    s_nop 0
    buffer_load_dwordx4 v150, s[28:31], s74 offen lds
    v_fma_f32 v233, v233, v227, -v231
    v_fma_f32 v234, v234, v227, -v231
    v_fma_f32 v235, v235, v227, -v231
    v_fma_f32 v236, v236, v227, -v231
    v_fma_f32 v237, v237, v227, -v231
    v_fma_f32 v238, v238, v227, -v231
    v_fma_f32 v239, v239, v227, -v231
    v_cvt_pk_bf16_f32 v116, v232, v233
    v_cvt_pk_bf16_f32 v117, v234, v235
    v_cvt_pk_bf16_f32 v118, v236, v237
    v_cvt_pk_bf16_f32 v119, v238, v239
    ds_write_b128 v243, v[116:119] offset:16384
    s_add_u32 m0, s72, 7168
    s_nop 0
    buffer_load_dwordx4 v151, s[28:31], s74 offen lds
    s_cmp_lt_u32 s21, 6
    s_cbranch_scc1 LL_D7
    s_add_u32 m0, s72, 8192
    s_nop 0
    buffer_load_dwordx4 v152, s[28:31], s74 offen lds
LL_D7:
    s_add_u32 s74, s74, s68
    s_add_u32 s72, s72, 37120
    s_cmp_eq_u32 s72, s73
    s_cselect_b32 s72, s71, s72
    s_waitcnt vmcnt(8) lgkmcnt(0)
    v_cmp_ne_u32 vcc, 1, v97
    s_cmp_eq_u64 vcc, 0
    s_cbranch_scc1 LL_POLL0_OK
    s_mov_b32 s70, 20000
    buffer_load_dword v97, v96, s[36:39], 0 offen sc1
LL_POLL0:
    s_waitcnt vmcnt(0)
    v_cmp_ne_u32 vcc, 1, v97
    s_cmp_eq_u64 vcc, 0
    s_cbranch_scc1 LL_POLL0_OK
    s_sleep 2
    buffer_load_dword v97, v96, s[36:39], 0 offen sc1
    s_sub_u32 s70, s70, 1
    s_cmp_lg_u32 s70, 0
    s_cbranch_scc1 LL_POLL0
LL_POLL0_OK:
    s_barrier
    s_add_u32 m0, s72, 0
    s_nop 0
    buffer_load_dwordx4 v144, s[28:31], s74 offen lds
    v_lshlrev_b32 v232, 16, v24
    v_and_b32 v233, 0xffff0000, v24
    v_lshlrev_b32 v234, 16, v25
    v_and_b32 v235, 0xffff0000, v25
    v_lshlrev_b32 v236, 16, v26
    v_and_b32 v237, 0xffff0000, v26
    v_lshlrev_b32 v238, 16, v27
    v_and_b32 v239, 0xffff0000, v27
    v_fma_f32 v232, v232, v224, -v228
    v_fma_f32 v233, v233, v224, -v228
    v_fma_f32 v234, v234, v224, -v228
    v_fma_f32 v235, v235, v224, -v228
    s_add_u32 m0, s72, 1024
    s_nop 0
    buffer_load_dwordx4 v145, s[28:31], s74 offen lds
    v_fma_f32 v236, v236, v224, -v228
    v_fma_f32 v237, v237, v224, -v228
    v_fma_f32 v238, v238, v224, -v228
    v_fma_f32 v239, v239, v224, -v228
    v_cvt_pk_bf16_f32 v24, v232, v233
    v_cvt_pk_bf16_f32 v25, v234, v235
    v_cvt_pk_bf16_f32 v26, v236, v237
    v_cvt_pk_bf16_f32 v27, v238, v239
    ds_write_b128 v240, v[24:27] offset:0
    v_lshlrev_b32 v232, 16, v56
    v_and_b32 v233, 0xffff0000, v56
    v_lshlrev_b32 v234, 16, v57
    s_add_u32 m0, s72, 2048
    s_nop 0
    buffer_load_dwordx4 v146, s[28:31], s74 offen lds
    v_and_b32 v235, 0xffff0000, v57
    v_lshlrev_b32 v236, 16, v58
    v_and_b32 v237, 0xffff0000, v58
    v_lshlrev_b32 v238, 16, v59
    v_and_b32 v239, 0xffff0000, v59
    v_fma_f32 v232, v232, v225, -v229
    v_fma_f32 v233, v233, v225, -v229
    v_fma_f32 v234, v234, v225, -v229
    v_fma_f32 v235, v235, v225, -v229
    v_fma_f32 v236, v236, v225, -v229
    v_fma_f32 v237, v237, v225, -v229
    v_fma_f32 v238, v238, v225, -v229
    s_add_u32 m0, s72, 3072
    s_nop 0
    buffer_load_dwordx4 v147, s[28:31], s74 offen lds
    v_fma_f32 v239, v239, v225, -v229
    v_cvt_pk_bf16_f32 v56, v232, v233
    v_cvt_pk_bf16_f32 v57, v234, v235
    v_cvt_pk_bf16_f32 v58, v236, v237
    v_cvt_pk_bf16_f32 v59, v238, v239
    ds_write_b128 v241, v[56:59] offset:0
    v_lshlrev_b32 v232, 16, v88
    v_and_b32 v233, 0xffff0000, v88
    v_lshlrev_b32 v234, 16, v89
    v_and_b32 v235, 0xffff0000, v89
    v_lshlrev_b32 v236, 16, v90
    v_and_b32 v237, 0xffff0000, v90
    s_add_u32 m0, s72, 4096
    s_nop 0
    buffer_load_dwordx4 v148, s[28:31], s74 offen lds
    v_lshlrev_b32 v238, 16, v91
    v_and_b32 v239, 0xffff0000, v91
    v_fma_f32 v232, v232, v226, -v230
    v_fma_f32 v233, v233, v226, -v230
    v_fma_f32 v234, v234, v226, -v230
    v_fma_f32 v235, v235, v226, -v230
    v_fma_f32 v236, v236, v226, -v230
    v_fma_f32 v237, v237, v226, -v230
    v_fma_f32 v238, v238, v226, -v230
    v_fma_f32 v239, v239, v226, -v230
    v_cvt_pk_bf16_f32 v88, v232, v233
    v_cvt_pk_bf16_f32 v89, v234, v235
    s_add_u32 m0, s72, 5120
    s_nop 0
    buffer_load_dwordx4 v149, s[28:31], s74 offen lds
    v_cvt_pk_bf16_f32 v90, v236, v237
    v_cvt_pk_bf16_f32 v91, v238, v239
    ds_write_b128 v242, v[88:91] offset:0
    v_lshlrev_b32 v232, 16, v120
    v_and_b32 v233, 0xffff0000, v120
    v_lshlrev_b32 v234, 16, v121
    v_and_b32 v235, 0xffff0000, v121
    v_lshlrev_b32 v236, 16, v122
    v_and_b32 v237, 0xffff0000, v122
    v_lshlrev_b32 v238, 16, v123
    v_and_b32 v239, 0xffff0000, v123
    v_fma_f32 v232, v232, v227, -v231
    s_add_u32 m0, s72, 6144
    s_nop 0
    buffer_load_dwordx4 v150, s[28:31], s74 offen lds
    v_fma_f32 v233, v233, v227, -v231
    v_fma_f32 v234, v234, v227, -v231
    v_fma_f32 v235, v235, v227, -v231
    v_fma_f32 v236, v236, v227, -v231
    v_fma_f32 v237, v237, v227, -v231
    v_fma_f32 v238, v238, v227, -v231
    v_fma_f32 v239, v239, v227, -v231
    v_cvt_pk_bf16_f32 v120, v232, v233
    v_cvt_pk_bf16_f32 v121, v234, v235
    v_cvt_pk_bf16_f32 v122, v236, v237
    v_cvt_pk_bf16_f32 v123, v238, v239
    ds_write_b128 v243, v[120:123] offset:0
    s_add_u32 m0, s72, 7168
    s_nop 0
    buffer_load_dwordx4 v151, s[28:31], s74 offen lds
    s_cmp_lt_u32 s21, 6
    s_cbranch_scc1 LL_D8
    s_add_u32 m0, s72, 8192
    s_nop 0
    buffer_load_dwordx4 v152, s[28:31], s74 offen lds
LL_D8:
    s_add_u32 s74, s74, s68
    s_add_u32 s72, s72, 37120
    s_cmp_eq_u32 s72, s73
    s_cselect_b32 s72, s71, s72
    s_waitcnt vmcnt(8) lgkmcnt(0)
    s_barrier
    v_lshlrev_b32 v232, 16, v28
    v_and_b32 v233, 0xffff0000, v28
    v_lshlrev_b32 v234, 16, v29
    v_and_b32 v235, 0xffff0000, v29
    v_lshlrev_b32 v236, 16, v30
    v_and_b32 v237, 0xffff0000, v30
    v_lshlrev_b32 v238, 16, v31
    v_and_b32 v239, 0xffff0000, v31
    v_fma_f32 v232, v232, v224, -v228
    v_fma_f32 v233, v233, v224, -v228
    v_fma_f32 v234, v234, v224, -v228
    v_fma_f32 v235, v235, v224, -v228
    v_fma_f32 v236, v236, v224, -v228
    v_fma_f32 v237, v237, v224, -v228
    v_fma_f32 v238, v238, v224, -v228
    v_fma_f32 v239, v239, v224, -v228
    v_cvt_pk_bf16_f32 v28, v232, v233
    v_cvt_pk_bf16_f32 v29, v234, v235
    v_cvt_pk_bf16_f32 v30, v236, v237
    v_cvt_pk_bf16_f32 v31, v238, v239
    ds_write_b128 v240, v[28:31] offset:16384
    v_lshlrev_b32 v232, 16, v60
    v_and_b32 v233, 0xffff0000, v60
    v_lshlrev_b32 v234, 16, v61
    v_and_b32 v235, 0xffff0000, v61
    v_lshlrev_b32 v236, 16, v62
    v_and_b32 v237, 0xffff0000, v62
    v_lshlrev_b32 v238, 16, v63
    v_and_b32 v239, 0xffff0000, v63
    v_fma_f32 v232, v232, v225, -v229
    v_fma_f32 v233, v233, v225, -v229
    v_fma_f32 v234, v234, v225, -v229
    v_fma_f32 v235, v235, v225, -v229
    v_fma_f32 v236, v236, v225, -v229
    v_fma_f32 v237, v237, v225, -v229
    v_fma_f32 v238, v238, v225, -v229
    v_fma_f32 v239, v239, v225, -v229
    v_cvt_pk_bf16_f32 v60, v232, v233
    v_cvt_pk_bf16_f32 v61, v234, v235
    v_cvt_pk_bf16_f32 v62, v236, v237
    v_cvt_pk_bf16_f32 v63, v238, v239
    ds_write_b128 v241, v[60:63] offset:16384
    v_lshlrev_b32 v232, 16, v92
    v_and_b32 v233, 0xffff0000, v92
    v_lshlrev_b32 v234, 16, v93
    v_and_b32 v235, 0xffff0000, v93
    v_lshlrev_b32 v236, 16, v94
    v_and_b32 v237, 0xffff0000, v94
    v_lshlrev_b32 v238, 16, v95
    v_and_b32 v239, 0xffff0000, v95
    v_fma_f32 v232, v232, v226, -v230
    v_fma_f32 v233, v233, v226, -v230
    v_fma_f32 v234, v234, v226, -v230
    v_fma_f32 v235, v235, v226, -v230
    v_fma_f32 v236, v236, v226, -v230
    v_fma_f32 v237, v237, v226, -v230
    v_fma_f32 v238, v238, v226, -v230
    v_fma_f32 v239, v239, v226, -v230
    v_cvt_pk_bf16_f32 v92, v232, v233
    v_cvt_pk_bf16_f32 v93, v234, v235
    v_cvt_pk_bf16_f32 v94, v236, v237
    v_cvt_pk_bf16_f32 v95, v238, v239
    ds_write_b128 v242, v[92:95] offset:16384
    v_lshlrev_b32 v232, 16, v124
    v_and_b32 v233, 0xffff0000, v124
    v_lshlrev_b32 v234, 16, v125
    v_and_b32 v235, 0xffff0000, v125
    v_lshlrev_b32 v236, 16, v126
    v_and_b32 v237, 0xffff0000, v126
    v_lshlrev_b32 v238, 16, v127
    v_and_b32 v239, 0xffff0000, v127
    v_fma_f32 v232, v232, v227, -v231
    v_fma_f32 v233, v233, v227, -v231
    v_fma_f32 v234, v234, v227, -v231
    v_fma_f32 v235, v235, v227, -v231
    v_fma_f32 v236, v236, v227, -v231
    v_fma_f32 v237, v237, v227, -v231
    v_fma_f32 v238, v238, v227, -v231
    v_fma_f32 v239, v239, v227, -v231
    v_cvt_pk_bf16_f32 v124, v232, v233
    v_cvt_pk_bf16_f32 v125, v234, v235
    v_cvt_pk_bf16_f32 v126, v236, v237
    v_cvt_pk_bf16_f32 v127, v238, v239
    ds_write_b128 v243, v[124:127] offset:16384
    s_waitcnt vmcnt(0) lgkmcnt(0)
    s_barrier
    s_mov_b32 s23, s79
    s_mul_i32 s75, s20, 10
    s_add_u32 s75, s75, s21
    s_sub_u32 s75, s75, 6
    s_mul_i32 s75, s75, 3
    s_add_u32 s75, s75, s60
    s_sub_u32 s75, s75, 1
    v_lshrrev_b32 v245, 5, v254
    v_lshlrev_b32 v245, 10, v245
    v_and_b32 v246, 31, v254
    v_lshl_add_u32 v245, v246, 4, v245
    s_add_u32 s90, s75, 0
    s_cmp_lt_u32 s90, 256
    s_cselect_b32 s28, s8, s16
    s_cselect_b32 s29, s9, s17
    s_mov_b32 s30, 0x158000
    s_cselect_b32 s30, 0x80000, s30
    s_mov_b32 s31, 0x00020000
    s_mov_b32 s91, 0x900000
    s_cselect_b32 s91, 0x800000, s91
    s_mov_b32 s67, 0x2b000
    s_cselect_b32 s67, 0x10000, s67
    s_cselect_b32 s70, 0, 256
    s_sub_u32 s70, s90, s70
    s_lshr_b32 s94, s70, 3
    s_and_b32 s70, s70, 7
    s_lshl_b32 s72, s94, 14
    s_lshl_b32 s95, s70, 7
    s_add_u32 s72, s72, s95
    s_mul_i32 s70, s70, s67
    s_lshl_b32 s94, s94, 11
    s_add_u32 s70, s70, s94
    s_add_u32 s70, s70, s91
    s_cmp_lt_u32 s90, 944
    s_cselect_b32 s92, s70, 0x7fff0000
    s_add_u32 s90, s75, 480
    s_cmp_lt_u32 s90, 256
    s_cselect_b32 s4, s8, s16
    s_cselect_b32 s5, s9, s17
    s_mov_b32 s6, 0x158000
    s_cselect_b32 s6, 0x80000, s6
    s_mov_b32 s7, 0x00020000
    s_mov_b32 s91, 0x900000
    s_cselect_b32 s91, 0x800000, s91
    s_mov_b32 s67, 0x2b000
    s_cselect_b32 s67, 0x10000, s67
    s_cselect_b32 s70, 0, 256
    s_sub_u32 s70, s90, s70
    s_lshr_b32 s94, s70, 3
    s_and_b32 s70, s70, 7
    s_lshl_b32 s73, s94, 14
    s_lshl_b32 s95, s70, 7
    s_add_u32 s73, s73, s95
    s_mul_i32 s70, s70, s67
    s_lshl_b32 s94, s94, 11
    s_add_u32 s70, s70, s94
    s_add_u32 s70, s70, s91
    s_cmp_lt_u32 s90, 944
    s_cselect_b32 s93, s70, 0x7fff0000
    s_call_b64 s[76:77], L_ATTINIT
    v_lshlrev_b32 v95, 4, v254
    v_mov_b32 v92, 0xdddd
    v_and_b32 v98, 15, v254
    v_lshlrev_b32 v98, 4, v98
    v_lshrrev_b32 v99, 5, v254
    v_lshl_or_b32 v98, v99, 8, v98
    v_add_u32 v98, 65536, v98
    v_add_u32 v99, s15, v95
    v_add_u32 v102, s16, v95
    v_and_b32 v103, 7, v254
    v_mul_u32_u24 v103, 1056, v103
    v_lshrrev_b32 v100, 3, v254
    v_lshl_add_u32 v103, v100, 4, v103
    v_add_u32 v103, s17, v103
    v_mov_b32 v93, v95
    v_mov_b32 v94, v98
    v_mov_b32 v100, 0xff800000
    v_mov_b32 v101, 0xff800000
    v_mov_b32 v104, -1
    v_mov_b32 v105, -1
    v_mov_b32 v106, -1
    v_mov_b32 v107, -1
    s_barrier
    s_setprio 3
    s_cmp_eq_u32 s23, 0
    s_cbranch_scc1 LL_S7
    buffer_load_ushort v204, v244, s[28:31], s72 offen offset:0
    buffer_load_ushort v220, v244, s[28:31], s72 offen offset:1024
    buffer_load_ushort v205, v244, s[28:31], s72 offen offset:2048
    buffer_load_ushort v221, v244, s[28:31], s72 offen offset:3072
    s_add_u32 s72, s72, 4096
    buffer_load_ushort v208, v244, s[28:31], s72 offen offset:0
    buffer_load_ushort v224, v244, s[28:31], s72 offen offset:1024
    buffer_load_ushort v209, v244, s[28:31], s72 offen offset:2048
    buffer_load_ushort v225, v244, s[28:31], s72 offen offset:3072
    s_add_u32 s72, s72, 4096
    buffer_load_ushort v206, v244, s[28:31], s72 offen offset:0
    buffer_load_ushort v222, v244, s[28:31], s72 offen offset:1024
    buffer_load_ushort v207, v244, s[28:31], s72 offen offset:2048
    buffer_load_ushort v223, v244, s[28:31], s72 offen offset:3072
    s_add_u32 s72, s72, 4096
    buffer_load_ushort v210, v244, s[28:31], s72 offen offset:0
    buffer_load_ushort v226, v244, s[28:31], s72 offen offset:1024
    buffer_load_ushort v211, v244, s[28:31], s72 offen offset:2048
    buffer_load_ushort v227, v244, s[28:31], s72 offen offset:3072
    s_add_u32 s72, s72, 4096
    buffer_load_ushort v212, v244, s[4:7], s73 offen offset:0
    buffer_load_ushort v228, v244, s[4:7], s73 offen offset:1024
    buffer_load_ushort v213, v244, s[4:7], s73 offen offset:2048
    buffer_load_ushort v229, v244, s[4:7], s73 offen offset:3072
    s_add_u32 s73, s73, 4096
    buffer_load_ushort v216, v244, s[4:7], s73 offen offset:0
    buffer_load_ushort v232, v244, s[4:7], s73 offen offset:1024
    buffer_load_ushort v217, v244, s[4:7], s73 offen offset:2048
    buffer_load_ushort v233, v244, s[4:7], s73 offen offset:3072
    s_add_u32 s73, s73, 4096
    buffer_load_ushort v214, v244, s[4:7], s73 offen offset:0
    buffer_load_ushort v230, v244, s[4:7], s73 offen offset:1024
    buffer_load_ushort v215, v244, s[4:7], s73 offen offset:2048
    buffer_load_ushort v231, v244, s[4:7], s73 offen offset:3072
    s_add_u32 s73, s73, 4096
    buffer_load_ushort v218, v244, s[4:7], s73 offen offset:0
    buffer_load_ushort v234, v244, s[4:7], s73 offen offset:1024
    buffer_load_ushort v219, v244, s[4:7], s73 offen offset:2048
    buffer_load_ushort v235, v244, s[4:7], s73 offen offset:3072
    s_add_u32 s73, s73, 4096
LL_S7:
    s_cmp_lg_u32 s60, 0
    s_cbranch_scc1 LL_WAITGO
    v_mov_b32 v96, 0
    s_bfe_u32 s64, s2, 0x10004
    s_lshl_b32 s64, s64, 5
    s_and_b32 s65, s2, 15
    s_add_u32 s64, s64, s65
    s_bfe_u32 s65, s2, 0x10005
    s_lshl_b32 s65, s65, 4
    s_add_u32 s64, s64, s65
    s_lshl_b32 s64, s64, 7
    s_add_u32 s64, s64, 0x1102000
    s_mov_b32 s70, 20000
    v_mov_b32 v0, 0
    s_mov_b64 exec, 1
    buffer_atomic_add v0, v96, s[32:35], s64 offen sc0
    s_mov_b64 exec, -1
    s_sleep 3
    v_mov_b32 v1, 0
    s_mov_b64 exec, 1
    buffer_atomic_add v1, v96, s[32:35], s64 offen sc0
    s_mov_b64 exec, -1
    s_sleep 3
LL_POLL:
    v_mov_b32 v2, 0
    s_mov_b64 exec, 1
    buffer_atomic_add v2, v96, s[32:35], s64 offen sc0
    s_mov_b64 exec, -1
    s_waitcnt vmcnt(2)
    v_cmp_eq_u32 vcc, 48, v0
    s_cmp_eq_u64 vcc, 1
    s_cbranch_scc1 LL_POLL_OK
    s_sleep 3
    v_mov_b32 v0, 0
    s_mov_b64 exec, 1
    buffer_atomic_add v0, v96, s[32:35], s64 offen sc0
    s_mov_b64 exec, -1
    s_waitcnt vmcnt(2)
    v_cmp_eq_u32 vcc, 48, v1
    s_cmp_eq_u64 vcc, 1
    s_cbranch_scc1 LL_POLL_OK
    s_sleep 3
    v_mov_b32 v1, 0
    s_mov_b64 exec, 1
    buffer_atomic_add v1, v96, s[32:35], s64 offen sc0
    s_mov_b64 exec, -1
    s_waitcnt vmcnt(2)
    v_cmp_eq_u32 vcc, 48, v2
    s_cmp_eq_u64 vcc, 1
    s_cbranch_scc1 LL_POLL_OK
    s_sleep 3
    s_sub_u32 s70, s70, 1
    s_cmp_lg_u32 s70, 0
    s_cbranch_scc1 LL_POLL
LL_POLL_OK:
    v_mov_b32 v96, 163584
    v_mov_b32 v97, 1
    ds_write_b32 v96, v97 offset:4
    s_branch LL_GO
LL_WAITGO:
    v_mov_b32 v96, 163584
    s_mov_b32 s70, 320000
LL_WG1:
    ds_read_b32 v97, v96 offset:4
    s_waitcnt lgkmcnt(0)
    v_readfirstlane_b32 s65, v97
    s_cmp_lg_u32 s65, 0
    s_cbranch_scc1 LL_GO
    s_sleep 1
    s_sub_u32 s70, s70, 1
    s_cmp_lg_u32 s70, 0
    s_cbranch_scc1 LL_WG1
LL_GO:
    s_and_b32 s64, s2, 31
    s_lshl_b32 s64, s64, 16
    s_lshl_b32 s65, s60, 11
    s_add_u32 s64, s64, s65
    s_lshr_b32 s66, s2, 5
    s_lshl_b32 s66, s66, 13
    s_add_u32 s66, s66, s64
    s_add_u32 m0, s65, 135168
    s_add_u32 s67, s64, 0x200000
    buffer_load_dwordx4 v95, s[32:35], s66 offen sc1 lds
    buffer_load_dwordx4 v95, s[32:35], s66 offen offset:1024 sc1 lds
    s_add_u32 s68, s64, 0x400000
    s_add_u32 m0, s65, 0
    s_nop 0
    buffer_load_dwordx4 v95, s[32:35], s67 offen sc1 lds
    buffer_load_dwordx4 v95, s[32:35], s67 offen offset:1024 sc1 lds
    s_add_u32 m0, s65, 65536
    s_add_u32 s67, s67, 8192
    buffer_load_dwordx4 v95, s[32:35], s68 offen sc1 lds
    buffer_load_dwordx4 v95, s[32:35], s68 offen offset:1024 sc1 lds
    s_add_u32 s68, s68, 8192
    s_add_u32 m0, s65, 8192
    s_nop 0
    buffer_load_dwordx4 v95, s[32:35], s67 offen sc1 lds
    buffer_load_dwordx4 v95, s[32:35], s67 offen offset:1024 sc1 lds
    s_add_u32 m0, s65, 73728
    s_add_u32 s67, s67, 8192
    buffer_load_dwordx4 v95, s[32:35], s68 offen sc1 lds
    buffer_load_dwordx4 v95, s[32:35], s68 offen offset:1024 sc1 lds
    s_add_u32 s68, s68, 8192
    s_cmp_eq_u32 s23, 0
    s_cbranch_scc1 L_P0
    s_mov_b32 s57, s92
    s_add_u32 s58, s92, 512
    s_mov_b32 s59, s93
    s_add_u32 s10, s93, 512
    v_mov_b32 v249, v245
    s_waitcnt vmcnt(10)
    v_lshl_or_b32 v204, v220, 16, v204
    v_lshl_or_b32 v205, v221, 16, v205
    v_lshl_or_b32 v206, v222, 16, v206
    v_lshl_or_b32 v207, v223, 16, v207
    v_lshl_or_b32 v208, v224, 16, v208
    v_lshl_or_b32 v209, v225, 16, v209
    v_lshl_or_b32 v210, v226, 16, v210
    v_lshl_or_b32 v211, v227, 16, v211
    v_lshl_or_b32 v212, v228, 16, v212
    v_lshl_or_b32 v213, v229, 16, v213
    v_lshl_or_b32 v214, v230, 16, v214
    v_lshl_or_b32 v215, v231, 16, v215
    v_lshl_or_b32 v216, v232, 16, v216
    v_lshl_or_b32 v217, v233, 16, v217
    v_lshl_or_b32 v218, v234, 16, v218
    v_lshl_or_b32 v219, v235, 16, v219
    s_branch L_P0
L_COMPUTE:
    s_mov_b32 s23, 0
    s_cmp_lg_u32 s22, 0
    s_cbranch_scc1 L_INIT1
    v_mov_b32 v160, 0
    v_mov_b32 v161, 0
    v_mov_b32 v162, 0
    v_mov_b32 v163, 0
    v_mov_b32 v164, 163584
    ds_write_b128 v164, v[160:163]
    s_sub_u32 s61, s2, 132
    s_cmp_ge_u32 s61, 2
    s_cbranch_scc1 L_INIT1
    v_lshlrev_b32 v164, 7, v254
    s_lshl_b32 s60, s61, 13
    s_add_u32 s60, s60, 0x1100000
    buffer_store_dword v160, v164, s[32:35], s60 offen sc1
    s_nop 1
L_INIT1:
    v_mov_b32 v0, 0
    v_mov_b32 v1, 0
    v_mov_b32 v2, 0
    v_mov_b32 v3, 0
    v_mov_b32 v4, 0
    v_mov_b32 v5, 0
    v_mov_b32 v6, 0
    v_mov_b32 v7, 0
    v_mov_b32 v8, 0
    v_mov_b32 v9, 0
    v_mov_b32 v10, 0
    v_mov_b32 v11, 0
    v_mov_b32 v12, 0
    v_mov_b32 v13, 0
    v_mov_b32 v14, 0
    v_mov_b32 v15, 0
    v_mov_b32 v16, 0
    v_mov_b32 v17, 0
    v_mov_b32 v18, 0
    v_mov_b32 v19, 0
    v_mov_b32 v20, 0
    v_mov_b32 v21, 0
    v_mov_b32 v22, 0
    v_mov_b32 v23, 0
    v_mov_b32 v24, 0
    v_mov_b32 v25, 0
    v_mov_b32 v26, 0
    v_mov_b32 v27, 0
    v_mov_b32 v28, 0
    v_mov_b32 v29, 0
    v_mov_b32 v30, 0
    v_mov_b32 v31, 0
    v_mov_b32 v32, 0
    v_mov_b32 v33, 0
    v_mov_b32 v34, 0
    v_mov_b32 v35, 0
    v_mov_b32 v36, 0
    v_mov_b32 v37, 0
    v_mov_b32 v38, 0
    v_mov_b32 v39, 0
    v_mov_b32 v40, 0
    v_mov_b32 v41, 0
    v_mov_b32 v42, 0
    v_mov_b32 v43, 0
    v_mov_b32 v44, 0
    v_mov_b32 v45, 0
    v_mov_b32 v46, 0
    v_mov_b32 v47, 0
    v_mov_b32 v48, 0
    v_mov_b32 v49, 0
    v_mov_b32 v50, 0
    v_mov_b32 v51, 0
    v_mov_b32 v52, 0
    v_mov_b32 v53, 0
    v_mov_b32 v54, 0
    v_mov_b32 v55, 0
    v_mov_b32 v56, 0
    v_mov_b32 v57, 0
    v_mov_b32 v58, 0
    v_mov_b32 v59, 0
    v_mov_b32 v60, 0
    v_mov_b32 v61, 0
    v_mov_b32 v62, 0
    v_mov_b32 v63, 0
    v_mov_b32 v64, 0
    v_mov_b32 v65, 0
    v_mov_b32 v66, 0
    v_mov_b32 v67, 0
    v_mov_b32 v68, 0
    v_mov_b32 v69, 0
    v_mov_b32 v70, 0
    v_mov_b32 v71, 0
    v_mov_b32 v72, 0
    v_mov_b32 v73, 0
    v_mov_b32 v74, 0
    v_mov_b32 v75, 0
    v_mov_b32 v76, 0
    v_mov_b32 v77, 0
    v_mov_b32 v78, 0
    v_mov_b32 v79, 0
    v_mov_b32 v80, 0
    v_mov_b32 v81, 0
    v_mov_b32 v82, 0
    v_mov_b32 v83, 0
    v_mov_b32 v84, 0
    v_mov_b32 v85, 0
    v_mov_b32 v86, 0
    v_mov_b32 v87, 0
    v_mov_b32 v88, 0
    v_mov_b32 v89, 0
    v_mov_b32 v90, 0
    v_mov_b32 v91, 0
    v_mov_b32 v92, 0
    v_mov_b32 v93, 0
    v_mov_b32 v94, 0
    v_mov_b32 v95, 0
    v_mov_b32 v96, 0
    v_mov_b32 v97, 0
    v_mov_b32 v98, 0
    v_mov_b32 v99, 0
    v_mov_b32 v100, 0
    v_mov_b32 v101, 0
    v_mov_b32 v102, 0
    v_mov_b32 v103, 0
    v_mov_b32 v104, 0
    v_mov_b32 v105, 0
    v_mov_b32 v106, 0
    v_mov_b32 v107, 0
    v_mov_b32 v108, 0
    v_mov_b32 v109, 0
    v_mov_b32 v110, 0
    v_mov_b32 v111, 0
    v_mov_b32 v112, 0
    v_mov_b32 v113, 0
    v_mov_b32 v114, 0
    v_mov_b32 v115, 0
    v_mov_b32 v116, 0
    v_mov_b32 v117, 0
    v_mov_b32 v118, 0
    v_mov_b32 v119, 0
    v_mov_b32 v120, 0
    v_mov_b32 v121, 0
    v_mov_b32 v122, 0
    v_mov_b32 v123, 0
    v_mov_b32 v124, 0
    v_mov_b32 v125, 0
    v_mov_b32 v126, 0
    v_mov_b32 v127, 0
    v_mov_b32 v128, 0
    v_mov_b32 v129, 0
    v_mov_b32 v130, 0
    v_mov_b32 v131, 0
    v_mov_b32 v132, 0
    v_mov_b32 v133, 0
    v_mov_b32 v134, 0
    v_mov_b32 v135, 0
    v_mov_b32 v136, 0
    v_mov_b32 v137, 0
    v_mov_b32 v138, 0
    v_mov_b32 v139, 0
    v_mov_b32 v140, 0
    v_mov_b32 v141, 0
    v_mov_b32 v142, 0
    v_mov_b32 v143, 0
    s_call_b64 s[76:77], L_ATTINIT
    s_lshr_b32 s60, s22, 1
    s_and_b32 s61, s22, 1
    s_cmp_ge_u32 s21, 6
    s_cbranch_scc1 L_F
    s_cmp_ge_u32 s21, 4
    s_cbranch_scc1 L_V
    v_and_b32 v244, 31, v254
    v_lshrrev_b32 v245, 5, v254
    v_bfe_u32 v246, v244, 1, 3
    v_xor_b32 v246, v246, v245
    v_lshlrev_b32 v247, 7, v244
    s_lshl_b32 s62, s22, 12
    v_xor_b32 v248, 0, v246
    v_lshl_add_u32 v248, v248, 4, v247
    v_add_u32 v232, s62, v248
    v_xor_b32 v236, 0x1000, v232
    v_xor_b32 v248, 2, v246
    v_lshl_add_u32 v248, v248, 4, v247
    v_add_u32 v233, s62, v248
    v_xor_b32 v237, 0x1000, v233
    v_xor_b32 v248, 4, v246
    v_lshl_add_u32 v248, v248, 4, v247
    v_add_u32 v234, s62, v248
    v_xor_b32 v238, 0x1000, v234
    v_xor_b32 v248, 6, v246
    v_lshl_add_u32 v248, v248, 4, v247
    v_add_u32 v235, s62, v248
    v_xor_b32 v239, 0x1000, v235
    v_bfe_u32 v249, v254, 2, 2
    v_and_b32 v247, 3, v254
    v_lshlrev_b32 v247, 3, v247
    v_lshl_add_u32 v247, v249, 8, v247
    v_bfe_u32 v248, v254, 4, 1
    v_lshl_add_u32 v247, v248, 5, v247
    v_mul_u32_u24 v248, 2048, v245
    v_add_u32 v247, v247, v248
    v_add_u32 v247, 32768, v247
    s_mul_i32 s62, s61, 9344
    v_add_u32 v247, s62, v247
    v_xor_b32 v248, 0, v249
    v_lshl_add_u32 v240, v248, 6, v247
    v_xor_b32 v248, 1, v249
    v_lshl_add_u32 v241, v248, 6, v247
    v_xor_b32 v248, 2, v249
    v_lshl_add_u32 v242, v248, 6, v247
    v_xor_b32 v248, 3, v249
    v_lshl_add_u32 v243, v248, 6, v247
    v_and_b32 v250, 0x33, v254
    v_bfe_u32 v251, v254, 2, 1
    v_lshl_or_b32 v250, v251, 3, v250
    v_bfe_u32 v251, v254, 3, 1
    v_lshl_or_b32 v250, v251, 2, v250
    s_cmp_lt_u32 s21, 2
    s_cselect_b64 vcc, -1, 0
    v_cndmask_b32 v249, v250, v254, vcc
    v_lshlrev_b32 v249, 4, v249
    s_lshl_b32 s68, s20, 2
    s_add_u32 s68, s68, s22
    s_xor_b32 s69, s68, 1
    s_lshl_b32 s70, s21, 20
    s_lshl_b32 s71, s61, 19
    s_add_u32 s70, s70, s71
    s_lshl_b32 s68, s68, 10
    s_lshl_b32 s69, s69, 10
    s_add_u32 s68, s68, s70
    s_add_u32 s69, s69, s70
    s_mov_b32 s64, 0
    s_mov_b32 s65, 0
    s_waitcnt lgkmcnt(0)
    s_barrier
    ds_read_b128 v[176:179], v232
    ds_read_b64_tr_b16 v[192:193], v240 offset:0
    ds_read_b64_tr_b16 v[194:195], v240 offset:1024
    ds_read_b128 v[180:183], v236
    ds_read_b64_tr_b16 v[196:197], v241 offset:0
    ds_read_b64_tr_b16 v[198:199], v241 offset:1024
    ds_read_b64_tr_b16 v[200:201], v242 offset:0
    ds_read_b64_tr_b16 v[202:203], v242 offset:1024
    ds_read_b64_tr_b16 v[204:205], v243 offset:0
    ds_read_b64_tr_b16 v[206:207], v243 offset:1024
.p2align 6
L1QK_LOOP:
    s_waitcnt lgkmcnt(7)
    v_mfma_f32_32x32x16_bf16 v[0:15], v[192:195], v[176:179], v[0:15]
    ds_read_b128 v[184:187], v233
    ds_read_b64_tr_b16 v[212:213], v240 offset:4096
    s_waitcnt lgkmcnt(8)
    v_mfma_f32_32x32x16_bf16 v[16:31], v[192:195], v[180:183], v[16:31]
    ds_read_b64_tr_b16 v[214:215], v240 offset:5120
    ds_read_b128 v[188:191], v237
    s_waitcnt lgkmcnt(8)
    v_mfma_f32_32x32x16_bf16 v[32:47], v[196:199], v[176:179], v[32:47]
    ds_read_b64_tr_b16 v[216:217], v241 offset:4096
    ds_read_b64_tr_b16 v[218:219], v241 offset:5120
    v_mfma_f32_32x32x16_bf16 v[48:63], v[196:199], v[180:183], v[48:63]
    ds_read_b64_tr_b16 v[220:221], v242 offset:4096
    ds_read_b64_tr_b16 v[222:223], v242 offset:5120
    s_waitcnt lgkmcnt(10)
    v_mfma_f32_32x32x16_bf16 v[64:79], v[200:203], v[176:179], v[64:79]
    ds_read_b64_tr_b16 v[224:225], v243 offset:4096
    ds_read_b64_tr_b16 v[226:227], v243 offset:5120
    v_mfma_f32_32x32x16_bf16 v[80:95], v[200:203], v[180:183], v[80:95]
    v_xor_b32 v232, 0x4000, v232
    v_xor_b32 v236, 0x4000, v236
    s_waitcnt lgkmcnt(10)
    v_mfma_f32_32x32x16_bf16 v[96:111], v[204:207], v[176:179], v[96:111]
    v_xor_b32 v233, 0x4000, v233
    v_xor_b32 v237, 0x4000, v237
    v_mfma_f32_32x32x16_bf16 v[112:127], v[204:207], v[180:183], v[112:127]
    s_waitcnt lgkmcnt(7)
    v_mfma_f32_32x32x16_bf16 v[0:15], v[212:215], v[184:187], v[0:15]
    ds_read_b128 v[176:179], v234
    ds_read_b64_tr_b16 v[192:193], v240 offset:18560
    s_waitcnt lgkmcnt(8)
    v_mfma_f32_32x32x16_bf16 v[16:31], v[212:215], v[188:191], v[16:31]
    ds_read_b64_tr_b16 v[194:195], v240 offset:19584
    ds_read_b128 v[180:183], v238
    s_waitcnt lgkmcnt(8)
    v_mfma_f32_32x32x16_bf16 v[32:47], v[216:219], v[184:187], v[32:47]
    ds_read_b64_tr_b16 v[196:197], v241 offset:18560
    ds_read_b64_tr_b16 v[198:199], v241 offset:19584
    v_mfma_f32_32x32x16_bf16 v[48:63], v[216:219], v[188:191], v[48:63]
    ds_read_b64_tr_b16 v[200:201], v242 offset:18560
    ds_read_b64_tr_b16 v[202:203], v242 offset:19584
    s_waitcnt lgkmcnt(10)
    v_mfma_f32_32x32x16_bf16 v[64:79], v[220:223], v[184:187], v[64:79]
    ds_read_b64_tr_b16 v[204:205], v243 offset:18560
    ds_read_b64_tr_b16 v[206:207], v243 offset:19584
    v_mfma_f32_32x32x16_bf16 v[80:95], v[220:223], v[188:191], v[80:95]
    s_cmp_eq_u32 s65, 2
    s_mov_b32 s66, 0x9100
    s_cselect_b32 s66, 0xfffede00, s66
    s_waitcnt lgkmcnt(10)
    v_mfma_f32_32x32x16_bf16 v[96:111], v[224:227], v[184:187], v[96:111]
    v_xor_b32 v234, 0x4000, v234
    v_xor_b32 v238, 0x4000, v238
    v_mfma_f32_32x32x16_bf16 v[112:127], v[224:227], v[188:191], v[112:127]
    s_cselect_b32 s65, -1, s65
    s_add_u32 s65, s65, 1
    s_waitcnt lgkmcnt(7)
    v_mfma_f32_32x32x16_bf16 v[0:15], v[192:195], v[176:179], v[0:15]
    ds_read_b128 v[184:187], v235
    ds_read_b64_tr_b16 v[212:213], v240 offset:22656
    s_waitcnt lgkmcnt(8)
    v_mfma_f32_32x32x16_bf16 v[16:31], v[192:195], v[180:183], v[16:31]
    ds_read_b64_tr_b16 v[214:215], v240 offset:23680
    ds_read_b128 v[188:191], v239
    s_waitcnt lgkmcnt(8)
    v_mfma_f32_32x32x16_bf16 v[32:47], v[196:199], v[176:179], v[32:47]
    ds_read_b64_tr_b16 v[216:217], v241 offset:22656
    ds_read_b64_tr_b16 v[218:219], v241 offset:23680
    v_mfma_f32_32x32x16_bf16 v[48:63], v[196:199], v[180:183], v[48:63]
    ds_read_b64_tr_b16 v[220:221], v242 offset:22656
    ds_read_b64_tr_b16 v[222:223], v242 offset:23680
    s_waitcnt lgkmcnt(10)
    v_mfma_f32_32x32x16_bf16 v[64:79], v[200:203], v[176:179], v[64:79]
    ds_read_b64_tr_b16 v[224:225], v243 offset:22656
    ds_read_b64_tr_b16 v[226:227], v243 offset:23680
    v_mfma_f32_32x32x16_bf16 v[80:95], v[200:203], v[180:183], v[80:95]
    s_waitcnt lgkmcnt(10)
    v_mfma_f32_32x32x16_bf16 v[96:111], v[204:207], v[176:179], v[96:111]
    v_xor_b32 v235, 0x4000, v235
    v_xor_b32 v239, 0x4000, v239
    v_mfma_f32_32x32x16_bf16 v[112:127], v[204:207], v[180:183], v[112:127]
    v_add_u32 v240, s66, v240
    v_add_u32 v241, s66, v241
    v_add_u32 v242, s66, v242
    v_add_u32 v243, s66, v243
    s_waitcnt lgkmcnt(7)
    v_mfma_f32_32x32x16_bf16 v[0:15], v[212:215], v[184:187], v[0:15]
    s_waitcnt lgkmcnt(6)
    v_mfma_f32_32x32x16_bf16 v[16:31], v[212:215], v[188:191], v[16:31]
    s_waitcnt lgkmcnt(0)
    s_barrier
    ds_read_b128 v[176:179], v232
    ds_read_b64_tr_b16 v[192:193], v240 offset:0
    v_mfma_f32_32x32x16_bf16 v[32:47], v[216:219], v[184:187], v[32:47]
    ds_read_b64_tr_b16 v[194:195], v240 offset:1024
    ds_read_b128 v[180:183], v236
    v_mfma_f32_32x32x16_bf16 v[48:63], v[216:219], v[188:191], v[48:63]
    ds_read_b64_tr_b16 v[196:197], v241 offset:0
    ds_read_b64_tr_b16 v[198:199], v241 offset:1024
    v_mfma_f32_32x32x16_bf16 v[64:79], v[220:223], v[184:187], v[64:79]
    ds_read_b64_tr_b16 v[200:201], v242 offset:0
    ds_read_b64_tr_b16 v[202:203], v242 offset:1024
    v_mfma_f32_32x32x16_bf16 v[80:95], v[220:223], v[188:191], v[80:95]
    ds_read_b64_tr_b16 v[204:205], v243 offset:0
    ds_read_b64_tr_b16 v[206:207], v243 offset:1024
    v_mfma_f32_32x32x16_bf16 v[96:111], v[224:227], v[184:187], v[96:111]
    v_mfma_f32_32x32x16_bf16 v[112:127], v[224:227], v[188:191], v[112:127]
    s_add_u32 s64, s64, 1
    s_cmp_lt_u32 s64, 7
    s_cbranch_scc1 L1QK_LOOP
    s_waitcnt lgkmcnt(7)
    v_mfma_f32_32x32x16_bf16 v[0:15], v[192:195], v[176:179], v[0:15]
    ds_read_b128 v[184:187], v233
    ds_read_b128 v[188:191], v237
    s_waitcnt lgkmcnt(8)
    v_mfma_f32_32x32x16_bf16 v[16:31], v[192:195], v[180:183], v[16:31]
    ds_read_b64_tr_b16 v[212:213], v240 offset:4096
    ds_read_b64_tr_b16 v[214:215], v240 offset:5120
    s_waitcnt lgkmcnt(8)
    v_mfma_f32_32x32x16_bf16 v[32:47], v[196:199], v[176:179], v[32:47]
    ds_read_b128 v[128:131], v234
    ds_read_b128 v[132:135], v238
    v_mfma_f32_32x32x16_bf16 v[48:63], v[196:199], v[180:183], v[48:63]
    ds_read_b64_tr_b16 v[216:217], v240 offset:18560
    ds_read_b64_tr_b16 v[218:219], v240 offset:19584
    s_waitcnt lgkmcnt(10)
    v_mfma_f32_32x32x16_bf16 v[64:79], v[200:203], v[176:179], v[64:79]
    ds_read_b128 v[136:139], v235
    ds_read_b128 v[140:143], v239
    v_mfma_f32_32x32x16_bf16 v[80:95], v[200:203], v[180:183], v[80:95]
    ds_read_b64_tr_b16 v[220:221], v240 offset:22656
    ds_read_b64_tr_b16 v[222:223], v240 offset:23680
    s_waitcnt lgkmcnt(12)
    v_mfma_f32_32x32x16_bf16 v[96:111], v[204:207], v[176:179], v[96:111]
    v_mfma_f32_32x32x16_bf16 v[112:127], v[204:207], v[180:183], v[112:127]
    s_waitcnt lgkmcnt(0)
    v_mfma_f32_32x32x16_bf16 v[0:15], v[212:215], v[184:187], v[0:15]
    ds_read_b64_tr_b16 v[224:225], v241 offset:4096
    ds_read_b64_tr_b16 v[226:227], v241 offset:5120
    v_mfma_f32_32x32x16_bf16 v[16:31], v[212:215], v[188:191], v[16:31]
    ds_read_b64_tr_b16 v[228:229], v241 offset:18560
    ds_read_b64_tr_b16 v[230:231], v241 offset:19584
    v_mfma_f32_32x32x16_bf16 v[0:15], v[216:219], v[128:131], v[0:15]
    ds_read_b64_tr_b16 v[208:209], v241 offset:22656
    ds_read_b64_tr_b16 v[210:211], v241 offset:23680
    v_mfma_f32_32x32x16_bf16 v[16:31], v[216:219], v[132:135], v[16:31]
    v_mfma_f32_32x32x16_bf16 v[0:15], v[220:223], v[136:139], v[0:15]
    v_mfma_f32_32x32x16_bf16 v[16:31], v[220:223], v[140:143], v[16:31]
    s_waitcnt lgkmcnt(0)
    v_mfma_f32_32x32x16_bf16 v[32:47], v[224:227], v[184:187], v[32:47]
    ds_read_b64_tr_b16 v[212:213], v242 offset:4096
    ds_read_b64_tr_b16 v[214:215], v242 offset:5120
    v_mfma_f32_32x32x16_bf16 v[48:63], v[224:227], v[188:191], v[48:63]
    ds_read_b64_tr_b16 v[216:217], v242 offset:18560
    ds_read_b64_tr_b16 v[218:219], v242 offset:19584
    v_mfma_f32_32x32x16_bf16 v[32:47], v[228:231], v[128:131], v[32:47]
    ds_read_b64_tr_b16 v[220:221], v242 offset:22656
    ds_read_b64_tr_b16 v[222:223], v242 offset:23680
    s_nop 3
    v_cvt_pk_bf16_f32 v0, v0, v1
    v_cvt_pk_bf16_f32 v1, v2, v3
    v_cvt_pk_bf16_f32 v2, v4, v5
    v_cvt_pk_bf16_f32 v3, v6, v7
    v_mfma_f32_32x32x16_bf16 v[48:63], v[228:231], v[132:135], v[48:63]
    s_add_u32 s65, s68, 0
    buffer_store_dwordx4 v[0:3], v249, s[32:35], s65 offen sc1
    v_cvt_pk_bf16_f32 v8, v8, v9
    v_cvt_pk_bf16_f32 v9, v10, v11
    v_cvt_pk_bf16_f32 v10, v12, v13
    v_cvt_pk_bf16_f32 v11, v14, v15
    v_mfma_f32_32x32x16_bf16 v[32:47], v[208:211], v[136:139], v[32:47]
    s_add_u32 s65, s65, 65536
    buffer_store_dwordx4 v[8:11], v249, s[32:35], s65 offen sc1
    v_cvt_pk_bf16_f32 v16, v16, v17
    v_cvt_pk_bf16_f32 v17, v18, v19
    v_cvt_pk_bf16_f32 v18, v20, v21
    v_cvt_pk_bf16_f32 v19, v22, v23
    v_mfma_f32_32x32x16_bf16 v[48:63], v[208:211], v[140:143], v[48:63]
    s_add_u32 s65, s69, 0
    buffer_store_dwordx4 v[16:19], v249, s[32:35], s65 offen sc1
    v_cvt_pk_bf16_f32 v24, v24, v25
    v_cvt_pk_bf16_f32 v25, v26, v27
    v_cvt_pk_bf16_f32 v26, v28, v29
    v_cvt_pk_bf16_f32 v27, v30, v31
    s_waitcnt lgkmcnt(0)
    v_mfma_f32_32x32x16_bf16 v[64:79], v[212:215], v[184:187], v[64:79]
    ds_read_b64_tr_b16 v[224:225], v243 offset:4096
    ds_read_b64_tr_b16 v[226:227], v243 offset:5120
    s_add_u32 s65, s65, 65536
    buffer_store_dwordx4 v[24:27], v249, s[32:35], s65 offen sc1
    v_mfma_f32_32x32x16_bf16 v[80:95], v[212:215], v[188:191], v[80:95]
    ds_read_b64_tr_b16 v[228:229], v243 offset:18560
    ds_read_b64_tr_b16 v[230:231], v243 offset:19584
    v_mfma_f32_32x32x16_bf16 v[64:79], v[216:219], v[128:131], v[64:79]
    ds_read_b64_tr_b16 v[208:209], v243 offset:22656
    ds_read_b64_tr_b16 v[210:211], v243 offset:23680
    s_nop 3
    v_cvt_pk_bf16_f32 v32, v32, v33
    v_cvt_pk_bf16_f32 v33, v34, v35
    v_cvt_pk_bf16_f32 v34, v36, v37
    v_cvt_pk_bf16_f32 v35, v38, v39
    v_mfma_f32_32x32x16_bf16 v[80:95], v[216:219], v[132:135], v[80:95]
    s_add_u32 s65, s68, 131072
    buffer_store_dwordx4 v[32:35], v249, s[32:35], s65 offen sc1
    v_cvt_pk_bf16_f32 v40, v40, v41
    v_cvt_pk_bf16_f32 v41, v42, v43
    v_cvt_pk_bf16_f32 v42, v44, v45
    v_cvt_pk_bf16_f32 v43, v46, v47
    v_mfma_f32_32x32x16_bf16 v[64:79], v[220:223], v[136:139], v[64:79]
    s_add_u32 s65, s65, 65536
    buffer_store_dwordx4 v[40:43], v249, s[32:35], s65 offen sc1
    v_cvt_pk_bf16_f32 v48, v48, v49
    v_cvt_pk_bf16_f32 v49, v50, v51
    v_cvt_pk_bf16_f32 v50, v52, v53
    v_cvt_pk_bf16_f32 v51, v54, v55
    v_mfma_f32_32x32x16_bf16 v[80:95], v[220:223], v[140:143], v[80:95]
    s_add_u32 s65, s69, 131072
    buffer_store_dwordx4 v[48:51], v249, s[32:35], s65 offen sc1
    v_cvt_pk_bf16_f32 v56, v56, v57
    v_cvt_pk_bf16_f32 v57, v58, v59
    v_cvt_pk_bf16_f32 v58, v60, v61
    v_cvt_pk_bf16_f32 v59, v62, v63
    s_waitcnt lgkmcnt(0)
    s_barrier
    v_mfma_f32_32x32x16_bf16 v[96:111], v[224:227], v[184:187], v[96:111]
    s_add_u32 s65, s65, 65536
    buffer_store_dwordx4 v[56:59], v249, s[32:35], s65 offen sc1
    v_mfma_f32_32x32x16_bf16 v[112:127], v[224:227], v[188:191], v[112:127]
    v_mfma_f32_32x32x16_bf16 v[96:111], v[228:231], v[128:131], v[96:111]
    s_nop 3
    v_cvt_pk_bf16_f32 v64, v64, v65
    v_cvt_pk_bf16_f32 v65, v66, v67
    v_cvt_pk_bf16_f32 v66, v68, v69
    v_cvt_pk_bf16_f32 v67, v70, v71
    v_mfma_f32_32x32x16_bf16 v[112:127], v[228:231], v[132:135], v[112:127]
    s_add_u32 s65, s68, 262144
    buffer_store_dwordx4 v[64:67], v249, s[32:35], s65 offen sc1
    v_cvt_pk_bf16_f32 v72, v72, v73
    v_cvt_pk_bf16_f32 v73, v74, v75
    v_cvt_pk_bf16_f32 v74, v76, v77
    v_cvt_pk_bf16_f32 v75, v78, v79
    v_mfma_f32_32x32x16_bf16 v[96:111], v[208:211], v[136:139], v[96:111]
    s_add_u32 s65, s65, 65536
    buffer_store_dwordx4 v[72:75], v249, s[32:35], s65 offen sc1
    v_cvt_pk_bf16_f32 v80, v80, v81
    v_cvt_pk_bf16_f32 v81, v82, v83
    v_cvt_pk_bf16_f32 v82, v84, v85
    v_cvt_pk_bf16_f32 v83, v86, v87
    v_mfma_f32_32x32x16_bf16 v[112:127], v[208:211], v[140:143], v[112:127]
    s_add_u32 s65, s69, 262144
    buffer_store_dwordx4 v[80:83], v249, s[32:35], s65 offen sc1
    v_cvt_pk_bf16_f32 v88, v88, v89
    v_cvt_pk_bf16_f32 v89, v90, v91
    v_cvt_pk_bf16_f32 v90, v92, v93
    v_cvt_pk_bf16_f32 v91, v94, v95
    s_add_u32 s65, s65, 65536
    buffer_store_dwordx4 v[88:91], v249, s[32:35], s65 offen sc1
    s_nop 7
    v_cvt_pk_bf16_f32 v96, v96, v97
    v_cvt_pk_bf16_f32 v97, v98, v99
    v_cvt_pk_bf16_f32 v98, v100, v101
    v_cvt_pk_bf16_f32 v99, v102, v103
    s_add_u32 s65, s68, 393216
    buffer_store_dwordx4 v[96:99], v249, s[32:35], s65 offen sc1
    v_cvt_pk_bf16_f32 v104, v104, v105
    v_cvt_pk_bf16_f32 v105, v106, v107
    v_cvt_pk_bf16_f32 v106, v108, v109
    v_cvt_pk_bf16_f32 v107, v110, v111
    s_add_u32 s65, s65, 65536
    buffer_store_dwordx4 v[104:107], v249, s[32:35], s65 offen sc1
    v_cvt_pk_bf16_f32 v112, v112, v113
    v_cvt_pk_bf16_f32 v113, v114, v115
    v_cvt_pk_bf16_f32 v114, v116, v117
    v_cvt_pk_bf16_f32 v115, v118, v119
    s_add_u32 s65, s69, 393216
    buffer_store_dwordx4 v[112:115], v249, s[32:35], s65 offen sc1
    v_cvt_pk_bf16_f32 v120, v120, v121
    v_cvt_pk_bf16_f32 v121, v122, v123
    v_cvt_pk_bf16_f32 v122, v124, v125
    v_cvt_pk_bf16_f32 v123, v126, v127
    s_add_u32 s65, s65, 65536
    buffer_store_dwordx4 v[120:123], v249, s[32:35], s65 offen sc1
    s_branch L_SIGNAL
L_V:
    v_and_b32 v244, 31, v254
    v_lshrrev_b32 v245, 5, v254
    v_bfe_u32 v246, v244, 1, 3
    v_xor_b32 v246, v246, v245
    v_lshlrev_b32 v247, 7, v244
    s_lshl_b32 s62, s22, 12
    v_xor_b32 v248, 0, v246
    v_lshl_add_u32 v248, v248, 4, v247
    v_add_u32 v232, s62, v248
    v_xor_b32 v236, 0x1000, v232
    v_xor_b32 v248, 2, v246
    v_lshl_add_u32 v248, v248, 4, v247
    v_add_u32 v233, s62, v248
    v_xor_b32 v237, 0x1000, v233
    v_xor_b32 v248, 4, v246
    v_lshl_add_u32 v248, v248, 4, v247
    v_add_u32 v234, s62, v248
    v_xor_b32 v238, 0x1000, v234
    v_xor_b32 v248, 6, v246
    v_lshl_add_u32 v248, v248, 4, v247
    v_add_u32 v235, s62, v248
    v_xor_b32 v239, 0x1000, v235
    v_bfe_u32 v249, v254, 2, 2
    v_and_b32 v247, 3, v254
    v_lshlrev_b32 v247, 3, v247
    v_lshl_add_u32 v247, v249, 8, v247
    v_bfe_u32 v248, v254, 4, 1
    v_lshl_add_u32 v247, v248, 5, v247
    v_mul_u32_u24 v248, 2048, v245
    v_add_u32 v247, v247, v248
    v_add_u32 v247, 32768, v247
    s_mul_i32 s62, s61, 9344
    v_add_u32 v247, s62, v247
    v_xor_b32 v248, 0, v249
    v_lshl_add_u32 v240, v248, 6, v247
    v_xor_b32 v248, 1, v249
    v_lshl_add_u32 v241, v248, 6, v247
    v_xor_b32 v248, 2, v249
    v_lshl_add_u32 v242, v248, 6, v247
    v_xor_b32 v248, 3, v249
    v_lshl_add_u32 v243, v248, 6, v247
    v_and_b32 v249, 15, v254
    v_lshlrev_b32 v249, 4, v249
    v_lshl_or_b32 v249, v245, 8, v249
    v_bfe_u32 v250, v254, 4, 1
    v_lshl_or_b32 v249, v250, 16, v249
    s_lshl_b32 s68, s20, 2
    s_add_u32 s68, s68, s22
    s_xor_b32 s69, s68, 1
    s_lshl_b32 s70, s21, 20
    s_lshl_b32 s71, s61, 19
    s_add_u32 s70, s70, s71
    s_lshl_b32 s68, s68, 10
    s_lshl_b32 s69, s69, 10
    s_add_u32 s68, s68, s70
    s_add_u32 s69, s69, s70
    s_mov_b32 s64, 0
    s_mov_b32 s65, 0
    s_waitcnt lgkmcnt(0)
    s_barrier
    ds_read_b128 v[176:179], v232
    ds_read_b64_tr_b16 v[192:193], v240 offset:0
    ds_read_b64_tr_b16 v[194:195], v240 offset:1024
    ds_read_b128 v[180:183], v236
    ds_read_b64_tr_b16 v[196:197], v241 offset:0
    ds_read_b64_tr_b16 v[198:199], v241 offset:1024
    ds_read_b64_tr_b16 v[200:201], v242 offset:0
    ds_read_b64_tr_b16 v[202:203], v242 offset:1024
    ds_read_b64_tr_b16 v[204:205], v243 offset:0
    ds_read_b64_tr_b16 v[206:207], v243 offset:1024
.p2align 6
L1V_LOOP:
    s_waitcnt lgkmcnt(7)
    v_mfma_f32_32x32x16_bf16 v[0:15], v[176:179], v[192:195], v[0:15]
    ds_read_b128 v[184:187], v233
    ds_read_b64_tr_b16 v[212:213], v240 offset:4096
    s_waitcnt lgkmcnt(8)
    v_mfma_f32_32x32x16_bf16 v[16:31], v[180:183], v[192:195], v[16:31]
    ds_read_b64_tr_b16 v[214:215], v240 offset:5120
    ds_read_b128 v[188:191], v237
    s_waitcnt lgkmcnt(8)
    v_mfma_f32_32x32x16_bf16 v[32:47], v[176:179], v[196:199], v[32:47]
    ds_read_b64_tr_b16 v[216:217], v241 offset:4096
    ds_read_b64_tr_b16 v[218:219], v241 offset:5120
    v_mfma_f32_32x32x16_bf16 v[48:63], v[180:183], v[196:199], v[48:63]
    ds_read_b64_tr_b16 v[220:221], v242 offset:4096
    ds_read_b64_tr_b16 v[222:223], v242 offset:5120
    s_waitcnt lgkmcnt(10)
    v_mfma_f32_32x32x16_bf16 v[64:79], v[176:179], v[200:203], v[64:79]
    ds_read_b64_tr_b16 v[224:225], v243 offset:4096
    ds_read_b64_tr_b16 v[226:227], v243 offset:5120
    v_mfma_f32_32x32x16_bf16 v[80:95], v[180:183], v[200:203], v[80:95]
    v_xor_b32 v232, 0x4000, v232
    v_xor_b32 v236, 0x4000, v236
    s_waitcnt lgkmcnt(10)
    v_mfma_f32_32x32x16_bf16 v[96:111], v[176:179], v[204:207], v[96:111]
    v_xor_b32 v233, 0x4000, v233
    v_xor_b32 v237, 0x4000, v237
    v_mfma_f32_32x32x16_bf16 v[112:127], v[180:183], v[204:207], v[112:127]
    s_waitcnt lgkmcnt(7)
    v_mfma_f32_32x32x16_bf16 v[0:15], v[184:187], v[212:215], v[0:15]
    ds_read_b128 v[176:179], v234
    ds_read_b64_tr_b16 v[192:193], v240 offset:18560
    s_waitcnt lgkmcnt(8)
    v_mfma_f32_32x32x16_bf16 v[16:31], v[188:191], v[212:215], v[16:31]
    ds_read_b64_tr_b16 v[194:195], v240 offset:19584
    ds_read_b128 v[180:183], v238
    s_waitcnt lgkmcnt(8)
    v_mfma_f32_32x32x16_bf16 v[32:47], v[184:187], v[216:219], v[32:47]
    ds_read_b64_tr_b16 v[196:197], v241 offset:18560
    ds_read_b64_tr_b16 v[198:199], v241 offset:19584
    v_mfma_f32_32x32x16_bf16 v[48:63], v[188:191], v[216:219], v[48:63]
    ds_read_b64_tr_b16 v[200:201], v242 offset:18560
    ds_read_b64_tr_b16 v[202:203], v242 offset:19584
    s_waitcnt lgkmcnt(10)
    v_mfma_f32_32x32x16_bf16 v[64:79], v[184:187], v[220:223], v[64:79]
    ds_read_b64_tr_b16 v[204:205], v243 offset:18560
    ds_read_b64_tr_b16 v[206:207], v243 offset:19584
    v_mfma_f32_32x32x16_bf16 v[80:95], v[188:191], v[220:223], v[80:95]
    s_cmp_eq_u32 s65, 2
    s_mov_b32 s66, 0x9100
    s_cselect_b32 s66, 0xfffede00, s66
    s_waitcnt lgkmcnt(10)
    v_mfma_f32_32x32x16_bf16 v[96:111], v[184:187], v[224:227], v[96:111]
    v_xor_b32 v234, 0x4000, v234
    v_xor_b32 v238, 0x4000, v238
    v_mfma_f32_32x32x16_bf16 v[112:127], v[188:191], v[224:227], v[112:127]
    s_cselect_b32 s65, -1, s65
    s_add_u32 s65, s65, 1
    s_waitcnt lgkmcnt(7)
    v_mfma_f32_32x32x16_bf16 v[0:15], v[176:179], v[192:195], v[0:15]
    ds_read_b128 v[184:187], v235
    ds_read_b64_tr_b16 v[212:213], v240 offset:22656
    s_waitcnt lgkmcnt(8)
    v_mfma_f32_32x32x16_bf16 v[16:31], v[180:183], v[192:195], v[16:31]
    ds_read_b64_tr_b16 v[214:215], v240 offset:23680
    ds_read_b128 v[188:191], v239
    s_waitcnt lgkmcnt(8)
    v_mfma_f32_32x32x16_bf16 v[32:47], v[176:179], v[196:199], v[32:47]
    ds_read_b64_tr_b16 v[216:217], v241 offset:22656
    ds_read_b64_tr_b16 v[218:219], v241 offset:23680
    v_mfma_f32_32x32x16_bf16 v[48:63], v[180:183], v[196:199], v[48:63]
    ds_read_b64_tr_b16 v[220:221], v242 offset:22656
    ds_read_b64_tr_b16 v[222:223], v242 offset:23680
    s_waitcnt lgkmcnt(10)
    v_mfma_f32_32x32x16_bf16 v[64:79], v[176:179], v[200:203], v[64:79]
    ds_read_b64_tr_b16 v[224:225], v243 offset:22656
    ds_read_b64_tr_b16 v[226:227], v243 offset:23680
    v_mfma_f32_32x32x16_bf16 v[80:95], v[180:183], v[200:203], v[80:95]
    s_waitcnt lgkmcnt(10)
    v_mfma_f32_32x32x16_bf16 v[96:111], v[176:179], v[204:207], v[96:111]
    v_xor_b32 v235, 0x4000, v235
    v_xor_b32 v239, 0x4000, v239
    v_mfma_f32_32x32x16_bf16 v[112:127], v[180:183], v[204:207], v[112:127]
    v_add_u32 v240, s66, v240
    v_add_u32 v241, s66, v241
    v_add_u32 v242, s66, v242
    v_add_u32 v243, s66, v243
    s_waitcnt lgkmcnt(7)
    v_mfma_f32_32x32x16_bf16 v[0:15], v[184:187], v[212:215], v[0:15]
    s_waitcnt lgkmcnt(6)
    v_mfma_f32_32x32x16_bf16 v[16:31], v[188:191], v[212:215], v[16:31]
    s_waitcnt lgkmcnt(0)
    s_barrier
    ds_read_b128 v[176:179], v232
    ds_read_b64_tr_b16 v[192:193], v240 offset:0
    v_mfma_f32_32x32x16_bf16 v[32:47], v[184:187], v[216:219], v[32:47]
    ds_read_b64_tr_b16 v[194:195], v240 offset:1024
    ds_read_b128 v[180:183], v236
    v_mfma_f32_32x32x16_bf16 v[48:63], v[188:191], v[216:219], v[48:63]
    ds_read_b64_tr_b16 v[196:197], v241 offset:0
    ds_read_b64_tr_b16 v[198:199], v241 offset:1024
    v_mfma_f32_32x32x16_bf16 v[64:79], v[184:187], v[220:223], v[64:79]
    ds_read_b64_tr_b16 v[200:201], v242 offset:0
    ds_read_b64_tr_b16 v[202:203], v242 offset:1024
    v_mfma_f32_32x32x16_bf16 v[80:95], v[188:191], v[220:223], v[80:95]
    ds_read_b64_tr_b16 v[204:205], v243 offset:0
    ds_read_b64_tr_b16 v[206:207], v243 offset:1024
    v_mfma_f32_32x32x16_bf16 v[96:111], v[184:187], v[224:227], v[96:111]
    v_mfma_f32_32x32x16_bf16 v[112:127], v[188:191], v[224:227], v[112:127]
    s_add_u32 s64, s64, 1
    s_cmp_lt_u32 s64, 7
    s_cbranch_scc1 L1V_LOOP
    s_waitcnt lgkmcnt(7)
    v_mfma_f32_32x32x16_bf16 v[0:15], v[176:179], v[192:195], v[0:15]
    ds_read_b128 v[184:187], v233
    ds_read_b128 v[188:191], v237
    s_waitcnt lgkmcnt(8)
    v_mfma_f32_32x32x16_bf16 v[16:31], v[180:183], v[192:195], v[16:31]
    ds_read_b64_tr_b16 v[212:213], v240 offset:4096
    ds_read_b64_tr_b16 v[214:215], v240 offset:5120
    s_waitcnt lgkmcnt(8)
    v_mfma_f32_32x32x16_bf16 v[32:47], v[176:179], v[196:199], v[32:47]
    ds_read_b128 v[128:131], v234
    ds_read_b128 v[132:135], v238
    v_mfma_f32_32x32x16_bf16 v[48:63], v[180:183], v[196:199], v[48:63]
    ds_read_b64_tr_b16 v[216:217], v240 offset:18560
    ds_read_b64_tr_b16 v[218:219], v240 offset:19584
    s_waitcnt lgkmcnt(10)
    v_mfma_f32_32x32x16_bf16 v[64:79], v[176:179], v[200:203], v[64:79]
    ds_read_b128 v[136:139], v235
    ds_read_b128 v[140:143], v239
    v_mfma_f32_32x32x16_bf16 v[80:95], v[180:183], v[200:203], v[80:95]
    ds_read_b64_tr_b16 v[220:221], v240 offset:22656
    ds_read_b64_tr_b16 v[222:223], v240 offset:23680
    s_waitcnt lgkmcnt(12)
    v_mfma_f32_32x32x16_bf16 v[96:111], v[176:179], v[204:207], v[96:111]
    v_mfma_f32_32x32x16_bf16 v[112:127], v[180:183], v[204:207], v[112:127]
    s_waitcnt lgkmcnt(0)
    v_mfma_f32_32x32x16_bf16 v[0:15], v[184:187], v[212:215], v[0:15]
    ds_read_b64_tr_b16 v[224:225], v241 offset:4096
    ds_read_b64_tr_b16 v[226:227], v241 offset:5120
    v_mfma_f32_32x32x16_bf16 v[16:31], v[188:191], v[212:215], v[16:31]
    ds_read_b64_tr_b16 v[228:229], v241 offset:18560
    ds_read_b64_tr_b16 v[230:231], v241 offset:19584
    v_mfma_f32_32x32x16_bf16 v[0:15], v[128:131], v[216:219], v[0:15]
    ds_read_b64_tr_b16 v[208:209], v241 offset:22656
    ds_read_b64_tr_b16 v[210:211], v241 offset:23680
    v_mfma_f32_32x32x16_bf16 v[16:31], v[132:135], v[216:219], v[16:31]
    v_mfma_f32_32x32x16_bf16 v[0:15], v[136:139], v[220:223], v[0:15]
    v_mfma_f32_32x32x16_bf16 v[16:31], v[140:143], v[220:223], v[16:31]
    s_waitcnt lgkmcnt(0)
    v_mfma_f32_32x32x16_bf16 v[32:47], v[184:187], v[224:227], v[32:47]
    ds_read_b64_tr_b16 v[212:213], v242 offset:4096
    ds_read_b64_tr_b16 v[214:215], v242 offset:5120
    v_mfma_f32_32x32x16_bf16 v[48:63], v[188:191], v[224:227], v[48:63]
    ds_read_b64_tr_b16 v[216:217], v242 offset:18560
    ds_read_b64_tr_b16 v[218:219], v242 offset:19584
    v_mfma_f32_32x32x16_bf16 v[32:47], v[128:131], v[228:231], v[32:47]
    ds_read_b64_tr_b16 v[220:221], v242 offset:22656
    ds_read_b64_tr_b16 v[222:223], v242 offset:23680
    s_nop 3
    v_cvt_pk_bf16_f32 v0, v0, v1
    v_cvt_pk_bf16_f32 v1, v2, v3
    v_cvt_pk_bf16_f32 v2, v4, v5
    v_cvt_pk_bf16_f32 v3, v6, v7
    v_mfma_f32_32x32x16_bf16 v[48:63], v[132:135], v[228:231], v[48:63]
    s_add_u32 s65, s68, 0
    buffer_store_dwordx4 v[0:3], v249, s[32:35], s65 offen sc1
    v_cvt_pk_bf16_f32 v8, v8, v9
    v_cvt_pk_bf16_f32 v9, v10, v11
    v_cvt_pk_bf16_f32 v10, v12, v13
    v_cvt_pk_bf16_f32 v11, v14, v15
    v_mfma_f32_32x32x16_bf16 v[32:47], v[136:139], v[208:211], v[32:47]
    buffer_store_dwordx4 v[8:11], v249, s[32:35], s65 offen offset:512 sc1
    v_cvt_pk_bf16_f32 v16, v16, v17
    v_cvt_pk_bf16_f32 v17, v18, v19
    v_cvt_pk_bf16_f32 v18, v20, v21
    v_cvt_pk_bf16_f32 v19, v22, v23
    v_mfma_f32_32x32x16_bf16 v[48:63], v[140:143], v[208:211], v[48:63]
    s_add_u32 s65, s69, 0
    buffer_store_dwordx4 v[16:19], v249, s[32:35], s65 offen sc1
    v_cvt_pk_bf16_f32 v24, v24, v25
    v_cvt_pk_bf16_f32 v25, v26, v27
    v_cvt_pk_bf16_f32 v26, v28, v29
    v_cvt_pk_bf16_f32 v27, v30, v31
    s_waitcnt lgkmcnt(0)
    v_mfma_f32_32x32x16_bf16 v[64:79], v[184:187], v[212:215], v[64:79]
    ds_read_b64_tr_b16 v[224:225], v243 offset:4096
    ds_read_b64_tr_b16 v[226:227], v243 offset:5120
    buffer_store_dwordx4 v[24:27], v249, s[32:35], s65 offen offset:512 sc1
    v_mfma_f32_32x32x16_bf16 v[80:95], v[188:191], v[212:215], v[80:95]
    ds_read_b64_tr_b16 v[228:229], v243 offset:18560
    ds_read_b64_tr_b16 v[230:231], v243 offset:19584
    v_mfma_f32_32x32x16_bf16 v[64:79], v[128:131], v[216:219], v[64:79]
    ds_read_b64_tr_b16 v[208:209], v243 offset:22656
    ds_read_b64_tr_b16 v[210:211], v243 offset:23680
    s_nop 3
    v_cvt_pk_bf16_f32 v32, v32, v33
    v_cvt_pk_bf16_f32 v33, v34, v35
    v_cvt_pk_bf16_f32 v34, v36, v37
    v_cvt_pk_bf16_f32 v35, v38, v39
    v_mfma_f32_32x32x16_bf16 v[80:95], v[132:135], v[216:219], v[80:95]
    s_add_u32 s65, s68, 131072
    buffer_store_dwordx4 v[32:35], v249, s[32:35], s65 offen sc1
    v_cvt_pk_bf16_f32 v40, v40, v41
    v_cvt_pk_bf16_f32 v41, v42, v43
    v_cvt_pk_bf16_f32 v42, v44, v45
    v_cvt_pk_bf16_f32 v43, v46, v47
    v_mfma_f32_32x32x16_bf16 v[64:79], v[136:139], v[220:223], v[64:79]
    buffer_store_dwordx4 v[40:43], v249, s[32:35], s65 offen offset:512 sc1
    v_cvt_pk_bf16_f32 v48, v48, v49
    v_cvt_pk_bf16_f32 v49, v50, v51
    v_cvt_pk_bf16_f32 v50, v52, v53
    v_cvt_pk_bf16_f32 v51, v54, v55
    v_mfma_f32_32x32x16_bf16 v[80:95], v[140:143], v[220:223], v[80:95]
    s_add_u32 s65, s69, 131072
    buffer_store_dwordx4 v[48:51], v249, s[32:35], s65 offen sc1
    v_cvt_pk_bf16_f32 v56, v56, v57
    v_cvt_pk_bf16_f32 v57, v58, v59
    v_cvt_pk_bf16_f32 v58, v60, v61
    v_cvt_pk_bf16_f32 v59, v62, v63
    s_waitcnt lgkmcnt(0)
    s_barrier
    v_mfma_f32_32x32x16_bf16 v[96:111], v[184:187], v[224:227], v[96:111]
    buffer_store_dwordx4 v[56:59], v249, s[32:35], s65 offen offset:512 sc1
    v_mfma_f32_32x32x16_bf16 v[112:127], v[188:191], v[224:227], v[112:127]
    v_mfma_f32_32x32x16_bf16 v[96:111], v[128:131], v[228:231], v[96:111]
    s_nop 3
    v_cvt_pk_bf16_f32 v64, v64, v65
    v_cvt_pk_bf16_f32 v65, v66, v67
    v_cvt_pk_bf16_f32 v66, v68, v69
    v_cvt_pk_bf16_f32 v67, v70, v71
    v_mfma_f32_32x32x16_bf16 v[112:127], v[132:135], v[228:231], v[112:127]
    s_add_u32 s65, s68, 262144
    buffer_store_dwordx4 v[64:67], v249, s[32:35], s65 offen sc1
    v_cvt_pk_bf16_f32 v72, v72, v73
    v_cvt_pk_bf16_f32 v73, v74, v75
    v_cvt_pk_bf16_f32 v74, v76, v77
    v_cvt_pk_bf16_f32 v75, v78, v79
    v_mfma_f32_32x32x16_bf16 v[96:111], v[136:139], v[208:211], v[96:111]
    buffer_store_dwordx4 v[72:75], v249, s[32:35], s65 offen offset:512 sc1
    v_cvt_pk_bf16_f32 v80, v80, v81
    v_cvt_pk_bf16_f32 v81, v82, v83
    v_cvt_pk_bf16_f32 v82, v84, v85
    v_cvt_pk_bf16_f32 v83, v86, v87
    v_mfma_f32_32x32x16_bf16 v[112:127], v[140:143], v[208:211], v[112:127]
    s_add_u32 s65, s69, 262144
    buffer_store_dwordx4 v[80:83], v249, s[32:35], s65 offen sc1
    v_cvt_pk_bf16_f32 v88, v88, v89
    v_cvt_pk_bf16_f32 v89, v90, v91
    v_cvt_pk_bf16_f32 v90, v92, v93
    v_cvt_pk_bf16_f32 v91, v94, v95
    buffer_store_dwordx4 v[88:91], v249, s[32:35], s65 offen offset:512 sc1
    s_nop 7
    v_cvt_pk_bf16_f32 v96, v96, v97
    v_cvt_pk_bf16_f32 v97, v98, v99
    v_cvt_pk_bf16_f32 v98, v100, v101
    v_cvt_pk_bf16_f32 v99, v102, v103
    s_add_u32 s65, s68, 393216
    buffer_store_dwordx4 v[96:99], v249, s[32:35], s65 offen sc1
    v_cvt_pk_bf16_f32 v104, v104, v105
    v_cvt_pk_bf16_f32 v105, v106, v107
    v_cvt_pk_bf16_f32 v106, v108, v109
    v_cvt_pk_bf16_f32 v107, v110, v111
    buffer_store_dwordx4 v[104:107], v249, s[32:35], s65 offen offset:512 sc1
    v_cvt_pk_bf16_f32 v112, v112, v113
    v_cvt_pk_bf16_f32 v113, v114, v115
    v_cvt_pk_bf16_f32 v114, v116, v117
    v_cvt_pk_bf16_f32 v115, v118, v119
    s_add_u32 s65, s69, 393216
    buffer_store_dwordx4 v[112:115], v249, s[32:35], s65 offen sc1
    v_cvt_pk_bf16_f32 v120, v120, v121
    v_cvt_pk_bf16_f32 v121, v122, v123
    v_cvt_pk_bf16_f32 v122, v124, v125
    v_cvt_pk_bf16_f32 v123, v126, v127
    buffer_store_dwordx4 v[120:123], v249, s[32:35], s65 offen offset:512 sc1
L_SIGNAL:
    s_and_b32 s14, s21, 1
    s_lshl_b32 s14, s14, 12
    s_add_u32 s14, s14, 0x1102000
    s_waitcnt vmcnt(0)
    v_mov_b32 v96, 163584
    v_mov_b32 v97, 1
    s_mov_b64 exec, 1
    ds_add_rtn_u32 v100, v96, v97 offset:0
    s_waitcnt lgkmcnt(0)
    s_mov_b64 exec, -1
    v_readfirstlane_b32 s60, v100
    s_cmp_lg_u32 s60, 3
    s_cbranch_scc1 L_SIG2
    v_lshlrev_b32 v96, 7, v254
    s_mov_b32 exec_hi, 0
    buffer_atomic_add v97, v96, s[32:35], s14 offen
    s_mov_b64 exec, -1
L_SIG2:
    s_branch L_P2
L_F:
    v_and_b32 v244, 31, v254
    v_lshrrev_b32 v245, 5, v254
    v_bfe_u32 v246, v244, 1, 3
    v_xor_b32 v246, v246, v245
    v_lshlrev_b32 v247, 7, v244
    s_lshl_b32 s62, s22, 12
    v_xor_b32 v248, 0, v246
    v_lshl_add_u32 v248, v248, 4, v247
    v_add_u32 v232, s62, v248
    v_xor_b32 v236, 0x1000, v232
    v_xor_b32 v248, 2, v246
    v_lshl_add_u32 v248, v248, 4, v247
    v_add_u32 v233, s62, v248
    v_xor_b32 v237, 0x1000, v233
    v_xor_b32 v248, 4, v246
    v_lshl_add_u32 v248, v248, 4, v247
    v_add_u32 v234, s62, v248
    v_xor_b32 v238, 0x1000, v234
    v_xor_b32 v248, 6, v246
    v_lshl_add_u32 v248, v248, 4, v247
    v_add_u32 v235, s62, v248
    v_xor_b32 v239, 0x1000, v235
    v_bfe_u32 v249, v254, 2, 2
    v_mul_u32_u24 v249, 288, v249
    v_and_b32 v247, 3, v254
    v_lshl_add_u32 v247, v247, 3, v249
    v_bfe_u32 v248, v254, 4, 1
    v_mul_u32_u24 v248, 9344, v248
    v_add_u32 v247, v247, v248
    v_mul_u32_u24 v248, 2304, v245
    v_add_u32 v247, v247, v248
    v_add_u32 v247, 32768, v247
    s_mul_i32 s62, s61, 128
    v_add_u32 v240, s62, v247
    v_add_u32 v241, 256, v247
    v_lshlrev_b32 v249, 4, v254
    s_lshl_b32 s68, s20, 2
    s_add_u32 s68, s68, s22
    s_xor_b32 s69, s68, 1
    s_mul_i32 s62, s68, 88064
    s_mul_i32 s63, s69, 88064
    s_add_u32 s62, s62, 0xb00000
    s_add_u32 s63, s63, 0xb00000
    s_sub_u32 s64, s21, 6
    s_mul_i32 s64, s64, 9
    s_lshl_b32 s65, s61, 2
    s_add_u32 s65, s65, s64
    s_add_u32 s66, s65, 0
    s_lshl_b32 s67, s66, 10
    s_add_u32 s67, s67, s62
    s_cmp_lt_u32 s66, 86
    s_cselect_b32 s52, s67, 0x7fff0000
    s_add_u32 s66, s65, 0
    s_lshl_b32 s67, s66, 10
    s_add_u32 s67, s67, s63
    s_cmp_lt_u32 s66, 86
    s_cselect_b32 s53, s67, 0x7fff0000
    s_add_u32 s66, s65, 1
    s_lshl_b32 s67, s66, 10
    s_add_u32 s67, s67, s62
    s_cmp_lt_u32 s66, 86
    s_cselect_b32 s54, s67, 0x7fff0000
    s_add_u32 s66, s65, 1
    s_lshl_b32 s67, s66, 10
    s_add_u32 s67, s67, s63
    s_cmp_lt_u32 s66, 86
    s_cselect_b32 s55, s67, 0x7fff0000
    s_add_u32 s66, s65, 2
    s_lshl_b32 s67, s66, 10
    s_add_u32 s67, s67, s62
    s_cmp_lt_u32 s66, 86
    s_cselect_b32 s56, s67, 0x7fff0000
    s_add_u32 s66, s65, 2
    s_lshl_b32 s67, s66, 10
    s_add_u32 s67, s67, s63
    s_cmp_lt_u32 s66, 86
    s_cselect_b32 s57, s67, 0x7fff0000
    s_add_u32 s66, s65, 3
    s_lshl_b32 s67, s66, 10
    s_add_u32 s67, s67, s62
    s_cmp_lt_u32 s66, 86
    s_cselect_b32 s58, s67, 0x7fff0000
    s_add_u32 s66, s65, 3
    s_lshl_b32 s67, s66, 10
    s_add_u32 s67, s67, s63
    s_cmp_lt_u32 s66, 86
    s_cselect_b32 s59, s67, 0x7fff0000
    s_add_u32 s66, s64, 8
    s_lshl_b32 s67, s66, 10
    s_add_u32 s67, s67, s62
    s_cmp_lt_u32 s66, 86
    s_cselect_b32 s10, s67, 0x7fff0000
    s_mov_b32 s64, 0
    s_mov_b32 s65, 0
    s_waitcnt vmcnt(0) lgkmcnt(0)
    s_barrier
    ds_read_b128 v[176:179], v232
    ds_read_b64_tr_b16 v[192:193], v240 offset:0
    ds_read_b64_tr_b16 v[194:195], v240 offset:1152
    ds_read_b128 v[180:183], v236
    ds_read_b64_tr_b16 v[196:197], v240 offset:32
    ds_read_b64_tr_b16 v[198:199], v240 offset:1184
    ds_read_b64_tr_b16 v[200:201], v240 offset:64
    ds_read_b64_tr_b16 v[202:203], v240 offset:1216
    ds_read_b64_tr_b16 v[204:205], v240 offset:96
    ds_read_b64_tr_b16 v[206:207], v240 offset:1248
    ds_read_b64_tr_b16 v[208:209], v241 offset:0
    ds_read_b64_tr_b16 v[210:211], v241 offset:1152
    s_sub_u32 s66, s2, 132
    s_lshl_b32 s67, s22, 8
    s_add_u32 s66, s66, s67
    s_cmp_ge_u32 s66, 2
    s_cbranch_scc1 L1F_LOOP
    s_lshl_b32 s66, s66, 2
    s_mov_b64 exec, 1
    v_mov_b32 v250, 1
    v_mov_b32 v251, 0
    buffer_store_dword v250, v251, s[36:39], s66 offen sc1
    s_mov_b64 exec, -1
.p2align 6
L1F_LOOP:
    s_waitcnt lgkmcnt(9)
    v_mfma_f32_32x32x16_bf16 v[0:15], v[192:195], v[176:179], v[0:15]
    ds_read_b128 v[184:187], v233
    ds_read_b64_tr_b16 v[212:213], v240 offset:4608
    s_waitcnt lgkmcnt(10)
    v_mfma_f32_32x32x16_bf16 v[16:31], v[192:195], v[180:183], v[16:31]
    ds_read_b64_tr_b16 v[214:215], v240 offset:5760
    ds_read_b128 v[188:191], v237
    s_waitcnt lgkmcnt(10)
    v_mfma_f32_32x32x16_bf16 v[32:47], v[196:199], v[176:179], v[32:47]
    ds_read_b64_tr_b16 v[216:217], v240 offset:4640
    ds_read_b64_tr_b16 v[218:219], v240 offset:5792
    v_mfma_f32_32x32x16_bf16 v[48:63], v[196:199], v[180:183], v[48:63]
    ds_read_b64_tr_b16 v[220:221], v240 offset:4672
    ds_read_b64_tr_b16 v[222:223], v240 offset:5824
    s_waitcnt lgkmcnt(12)
    v_mfma_f32_32x32x16_bf16 v[64:79], v[200:203], v[176:179], v[64:79]
    ds_read_b64_tr_b16 v[224:225], v240 offset:4704
    ds_read_b64_tr_b16 v[226:227], v240 offset:5856
    v_mfma_f32_32x32x16_bf16 v[80:95], v[200:203], v[180:183], v[80:95]
    ds_read_b64_tr_b16 v[228:229], v241 offset:4608
    ds_read_b64_tr_b16 v[230:231], v241 offset:5760
    s_waitcnt lgkmcnt(14)
    v_mfma_f32_32x32x16_bf16 v[96:111], v[204:207], v[176:179], v[96:111]
    v_xor_b32 v232, 0x4000, v232
    v_xor_b32 v236, 0x4000, v236
    v_mfma_f32_32x32x16_bf16 v[112:127], v[204:207], v[180:183], v[112:127]
    v_xor_b32 v233, 0x4000, v233
    v_xor_b32 v237, 0x4000, v237
    s_waitcnt lgkmcnt(12)
    v_mfma_f32_32x32x16_bf16 v[128:143], v[208:211], v[176:179], v[128:143]
    s_waitcnt lgkmcnt(9)
    v_mfma_f32_32x32x16_bf16 v[0:15], v[212:215], v[184:187], v[0:15]
    ds_read_b128 v[176:179], v234
    ds_read_b64_tr_b16 v[192:193], v240 offset:18560
    s_waitcnt lgkmcnt(10)
    v_mfma_f32_32x32x16_bf16 v[16:31], v[212:215], v[188:191], v[16:31]
    ds_read_b64_tr_b16 v[194:195], v240 offset:19712
    ds_read_b128 v[180:183], v238
    s_waitcnt lgkmcnt(10)
    v_mfma_f32_32x32x16_bf16 v[32:47], v[216:219], v[184:187], v[32:47]
    ds_read_b64_tr_b16 v[196:197], v240 offset:18592
    ds_read_b64_tr_b16 v[198:199], v240 offset:19744
    v_mfma_f32_32x32x16_bf16 v[48:63], v[216:219], v[188:191], v[48:63]
    ds_read_b64_tr_b16 v[200:201], v240 offset:18624
    ds_read_b64_tr_b16 v[202:203], v240 offset:19776
    s_waitcnt lgkmcnt(12)
    v_mfma_f32_32x32x16_bf16 v[64:79], v[220:223], v[184:187], v[64:79]
    ds_read_b64_tr_b16 v[204:205], v240 offset:18656
    ds_read_b64_tr_b16 v[206:207], v240 offset:19808
    v_mfma_f32_32x32x16_bf16 v[80:95], v[220:223], v[188:191], v[80:95]
    ds_read_b64_tr_b16 v[208:209], v241 offset:18560
    ds_read_b64_tr_b16 v[210:211], v241 offset:19712
    s_waitcnt lgkmcnt(14)
    v_mfma_f32_32x32x16_bf16 v[96:111], v[224:227], v[184:187], v[96:111]
    s_cmp_eq_u32 s65, 2
    s_mov_b32 s66, 0x9100
    s_cselect_b32 s66, 0xfffede00, s66
    v_mfma_f32_32x32x16_bf16 v[112:127], v[224:227], v[188:191], v[112:127]
    v_xor_b32 v234, 0x4000, v234
    v_xor_b32 v238, 0x4000, v238
    s_waitcnt lgkmcnt(12)
    v_mfma_f32_32x32x16_bf16 v[128:143], v[228:231], v[184:187], v[128:143]
    s_cselect_b32 s65, -1, s65
    s_add_u32 s65, s65, 1
    s_waitcnt lgkmcnt(9)
    v_mfma_f32_32x32x16_bf16 v[0:15], v[192:195], v[176:179], v[0:15]
    ds_read_b128 v[184:187], v235
    ds_read_b64_tr_b16 v[212:213], v240 offset:23168
    s_waitcnt lgkmcnt(10)
    v_mfma_f32_32x32x16_bf16 v[16:31], v[192:195], v[180:183], v[16:31]
    ds_read_b64_tr_b16 v[214:215], v240 offset:24320
    ds_read_b128 v[188:191], v239
    s_waitcnt lgkmcnt(10)
    v_mfma_f32_32x32x16_bf16 v[32:47], v[196:199], v[176:179], v[32:47]
    ds_read_b64_tr_b16 v[216:217], v240 offset:23200
    ds_read_b64_tr_b16 v[218:219], v240 offset:24352
    v_mfma_f32_32x32x16_bf16 v[48:63], v[196:199], v[180:183], v[48:63]
    ds_read_b64_tr_b16 v[220:221], v240 offset:23232
    ds_read_b64_tr_b16 v[222:223], v240 offset:24384
    s_waitcnt lgkmcnt(12)
    v_mfma_f32_32x32x16_bf16 v[64:79], v[200:203], v[176:179], v[64:79]
    ds_read_b64_tr_b16 v[224:225], v240 offset:23264
    ds_read_b64_tr_b16 v[226:227], v240 offset:24416
    v_mfma_f32_32x32x16_bf16 v[80:95], v[200:203], v[180:183], v[80:95]
    ds_read_b64_tr_b16 v[228:229], v241 offset:23168
    ds_read_b64_tr_b16 v[230:231], v241 offset:24320
    s_waitcnt lgkmcnt(14)
    v_mfma_f32_32x32x16_bf16 v[96:111], v[204:207], v[176:179], v[96:111]
    v_mfma_f32_32x32x16_bf16 v[112:127], v[204:207], v[180:183], v[112:127]
    v_xor_b32 v235, 0x4000, v235
    v_xor_b32 v239, 0x4000, v239
    s_waitcnt lgkmcnt(12)
    v_mfma_f32_32x32x16_bf16 v[128:143], v[208:211], v[176:179], v[128:143]
    v_add_u32 v240, s66, v240
    v_add_u32 v241, s66, v241
    s_waitcnt lgkmcnt(9)
    v_mfma_f32_32x32x16_bf16 v[0:15], v[212:215], v[184:187], v[0:15]
    s_waitcnt lgkmcnt(8)
    v_mfma_f32_32x32x16_bf16 v[16:31], v[212:215], v[188:191], v[16:31]
    s_waitcnt lgkmcnt(0)
    s_barrier
    ds_read_b128 v[176:179], v232
    ds_read_b64_tr_b16 v[192:193], v240 offset:0
    v_mfma_f32_32x32x16_bf16 v[32:47], v[216:219], v[184:187], v[32:47]
    ds_read_b64_tr_b16 v[194:195], v240 offset:1152
    ds_read_b128 v[180:183], v236
    v_mfma_f32_32x32x16_bf16 v[48:63], v[216:219], v[188:191], v[48:63]
    ds_read_b64_tr_b16 v[196:197], v240 offset:32
    ds_read_b64_tr_b16 v[198:199], v240 offset:1184
    v_mfma_f32_32x32x16_bf16 v[64:79], v[220:223], v[184:187], v[64:79]
    ds_read_b64_tr_b16 v[200:201], v240 offset:64
    ds_read_b64_tr_b16 v[202:203], v240 offset:1216
    v_mfma_f32_32x32x16_bf16 v[80:95], v[220:223], v[188:191], v[80:95]
    ds_read_b64_tr_b16 v[204:205], v240 offset:96
    ds_read_b64_tr_b16 v[206:207], v240 offset:1248
    v_mfma_f32_32x32x16_bf16 v[96:111], v[224:227], v[184:187], v[96:111]
    ds_read_b64_tr_b16 v[208:209], v241 offset:0
    ds_read_b64_tr_b16 v[210:211], v241 offset:1152
    v_mfma_f32_32x32x16_bf16 v[112:127], v[224:227], v[188:191], v[112:127]
    v_mfma_f32_32x32x16_bf16 v[128:143], v[228:231], v[184:187], v[128:143]
    s_add_u32 s64, s64, 1
    s_cmp_lt_u32 s64, 8
    s_cbranch_scc1 L1F_LOOP
    s_waitcnt lgkmcnt(0)
    v_mov_b32 v220, 0xc0135761
    v_mov_b32 v221, 0xc0135761
    v_mov_b32 v222, 0xbdd2d3e8
    v_mov_b32 v223, 0xbdd2d3e8
    v_mov_b32 v224, 0x3f800000
    v_mov_b32 v225, 0x3f800000
    v_pk_mul_f32 v[232:233], v[0:1], v[0:1]
    v_pk_mul_f32 v[234:235], v[2:3], v[2:3]
    v_pk_mul_f32 v[236:237], v[4:5], v[4:5]
    v_pk_mul_f32 v[238:239], v[6:7], v[6:7]
    v_pk_fma_f32 v[232:233], v[232:233], v[222:223], v[220:221]
    v_pk_fma_f32 v[234:235], v[234:235], v[222:223], v[220:221]
    v_pk_fma_f32 v[236:237], v[236:237], v[222:223], v[220:221]
    v_pk_fma_f32 v[238:239], v[238:239], v[222:223], v[220:221]
    v_pk_mul_f32 v[232:233], v[232:233], v[0:1]
    v_pk_mul_f32 v[234:235], v[234:235], v[2:3]
    v_pk_mul_f32 v[236:237], v[236:237], v[4:5]
    v_pk_mul_f32 v[238:239], v[238:239], v[6:7]
    v_pk_mul_f32 v[0:1], v[0:1], v[8:9]
    v_pk_mul_f32 v[2:3], v[2:3], v[10:11]
    v_pk_mul_f32 v[4:5], v[4:5], v[12:13]
    v_pk_mul_f32 v[6:7], v[6:7], v[14:15]
    v_exp_f32 v232, v232
    v_exp_f32 v233, v233
    v_exp_f32 v234, v234
    v_exp_f32 v235, v235
    v_exp_f32 v236, v236
    v_exp_f32 v237, v237
    v_exp_f32 v238, v238
    v_exp_f32 v239, v239
    v_pk_mul_f32 v[176:177], v[16:17], v[16:17]
    v_pk_mul_f32 v[178:179], v[18:19], v[18:19]
    v_pk_mul_f32 v[180:181], v[20:21], v[20:21]
    v_pk_mul_f32 v[182:183], v[22:23], v[22:23]
    v_pk_fma_f32 v[176:177], v[176:177], v[222:223], v[220:221]
    v_pk_fma_f32 v[178:179], v[178:179], v[222:223], v[220:221]
    v_pk_fma_f32 v[180:181], v[180:181], v[222:223], v[220:221]
    v_pk_fma_f32 v[182:183], v[182:183], v[222:223], v[220:221]
    v_pk_mul_f32 v[176:177], v[176:177], v[16:17]
    v_pk_mul_f32 v[178:179], v[178:179], v[18:19]
    v_pk_mul_f32 v[180:181], v[180:181], v[20:21]
    v_pk_mul_f32 v[182:183], v[182:183], v[22:23]
    v_pk_mul_f32 v[16:17], v[16:17], v[24:25]
    v_pk_mul_f32 v[18:19], v[18:19], v[26:27]
    v_pk_mul_f32 v[20:21], v[20:21], v[28:29]
    v_pk_mul_f32 v[22:23], v[22:23], v[30:31]
    v_pk_add_f32 v[232:233], v[232:233], v[224:225]
    v_pk_add_f32 v[234:235], v[234:235], v[224:225]
    v_pk_add_f32 v[236:237], v[236:237], v[224:225]
    v_pk_add_f32 v[238:239], v[238:239], v[224:225]
    v_rcp_f32 v232, v232
    v_rcp_f32 v233, v233
    v_rcp_f32 v234, v234
    v_rcp_f32 v235, v235
    v_rcp_f32 v236, v236
    v_rcp_f32 v237, v237
    v_rcp_f32 v238, v238
    v_rcp_f32 v239, v239
    v_exp_f32 v176, v176
    v_exp_f32 v177, v177
    v_exp_f32 v178, v178
    v_exp_f32 v179, v179
    v_exp_f32 v180, v180
    v_exp_f32 v181, v181
    v_exp_f32 v182, v182
    v_exp_f32 v183, v183
    v_pk_mul_f32 v[0:1], v[0:1], v[232:233]
    v_pk_mul_f32 v[2:3], v[2:3], v[234:235]
    v_pk_mul_f32 v[4:5], v[4:5], v[236:237]
    v_pk_mul_f32 v[6:7], v[6:7], v[238:239]
    v_cvt_pk_bf16_f32 v184, v0, v1
    v_cvt_pk_bf16_f32 v185, v2, v3
    v_cvt_pk_bf16_f32 v186, v4, v5
    v_cvt_pk_bf16_f32 v187, v6, v7
    v_pk_mul_f32 v[232:233], v[32:33], v[32:33]
    v_pk_mul_f32 v[234:235], v[34:35], v[34:35]
    v_pk_mul_f32 v[236:237], v[36:37], v[36:37]
    v_pk_mul_f32 v[238:239], v[38:39], v[38:39]
    v_pk_fma_f32 v[232:233], v[232:233], v[222:223], v[220:221]
    v_pk_fma_f32 v[234:235], v[234:235], v[222:223], v[220:221]
    v_pk_fma_f32 v[236:237], v[236:237], v[222:223], v[220:221]
    v_pk_fma_f32 v[238:239], v[238:239], v[222:223], v[220:221]
    v_pk_mul_f32 v[232:233], v[232:233], v[32:33]
    v_pk_mul_f32 v[234:235], v[234:235], v[34:35]
    v_pk_mul_f32 v[236:237], v[236:237], v[36:37]
    v_pk_mul_f32 v[238:239], v[238:239], v[38:39]
    v_pk_mul_f32 v[32:33], v[32:33], v[40:41]
    v_pk_mul_f32 v[34:35], v[34:35], v[42:43]
    v_pk_mul_f32 v[36:37], v[36:37], v[44:45]
    v_pk_mul_f32 v[38:39], v[38:39], v[46:47]
    v_pk_add_f32 v[176:177], v[176:177], v[224:225]
    v_pk_add_f32 v[178:179], v[178:179], v[224:225]
    v_pk_add_f32 v[180:181], v[180:181], v[224:225]
    v_pk_add_f32 v[182:183], v[182:183], v[224:225]
    v_rcp_f32 v176, v176
    v_rcp_f32 v177, v177
    v_rcp_f32 v178, v178
    v_rcp_f32 v179, v179
    v_rcp_f32 v180, v180
    v_rcp_f32 v181, v181
    v_rcp_f32 v182, v182
    v_rcp_f32 v183, v183
    v_exp_f32 v232, v232
    v_exp_f32 v233, v233
    v_exp_f32 v234, v234
    v_exp_f32 v235, v235
    v_exp_f32 v236, v236
    v_exp_f32 v237, v237
    v_exp_f32 v238, v238
    v_exp_f32 v239, v239
    v_pk_mul_f32 v[16:17], v[16:17], v[176:177]
    v_pk_mul_f32 v[18:19], v[18:19], v[178:179]
    v_pk_mul_f32 v[20:21], v[20:21], v[180:181]
    v_pk_mul_f32 v[22:23], v[22:23], v[182:183]
    v_cvt_pk_bf16_f32 v188, v16, v17
    v_cvt_pk_bf16_f32 v189, v18, v19
    v_cvt_pk_bf16_f32 v190, v20, v21
    v_cvt_pk_bf16_f32 v191, v22, v23
    v_pk_mul_f32 v[176:177], v[48:49], v[48:49]
    v_pk_mul_f32 v[178:179], v[50:51], v[50:51]
    v_pk_mul_f32 v[180:181], v[52:53], v[52:53]
    v_pk_mul_f32 v[182:183], v[54:55], v[54:55]
    v_pk_fma_f32 v[176:177], v[176:177], v[222:223], v[220:221]
    v_pk_fma_f32 v[178:179], v[178:179], v[222:223], v[220:221]
    v_pk_fma_f32 v[180:181], v[180:181], v[222:223], v[220:221]
    v_pk_fma_f32 v[182:183], v[182:183], v[222:223], v[220:221]
    v_pk_mul_f32 v[176:177], v[176:177], v[48:49]
    v_pk_mul_f32 v[178:179], v[178:179], v[50:51]
    v_pk_mul_f32 v[180:181], v[180:181], v[52:53]
    v_pk_mul_f32 v[182:183], v[182:183], v[54:55]
    v_pk_mul_f32 v[48:49], v[48:49], v[56:57]
    v_pk_mul_f32 v[50:51], v[50:51], v[58:59]
    v_pk_mul_f32 v[52:53], v[52:53], v[60:61]
    v_pk_mul_f32 v[54:55], v[54:55], v[62:63]
    v_pk_add_f32 v[232:233], v[232:233], v[224:225]
    v_pk_add_f32 v[234:235], v[234:235], v[224:225]
    v_pk_add_f32 v[236:237], v[236:237], v[224:225]
    v_pk_add_f32 v[238:239], v[238:239], v[224:225]
    v_rcp_f32 v232, v232
    v_rcp_f32 v233, v233
    v_rcp_f32 v234, v234
    v_rcp_f32 v235, v235
    v_rcp_f32 v236, v236
    v_rcp_f32 v237, v237
    v_rcp_f32 v238, v238
    v_rcp_f32 v239, v239
    v_exp_f32 v176, v176
    v_exp_f32 v177, v177
    v_exp_f32 v178, v178
    v_exp_f32 v179, v179
    v_exp_f32 v180, v180
    v_exp_f32 v181, v181
    v_exp_f32 v182, v182
    v_exp_f32 v183, v183
    v_pk_mul_f32 v[32:33], v[32:33], v[232:233]
    v_pk_mul_f32 v[34:35], v[34:35], v[234:235]
    v_pk_mul_f32 v[36:37], v[36:37], v[236:237]
    v_pk_mul_f32 v[38:39], v[38:39], v[238:239]
    v_cvt_pk_bf16_f32 v192, v32, v33
    v_cvt_pk_bf16_f32 v193, v34, v35
    v_cvt_pk_bf16_f32 v194, v36, v37
    v_cvt_pk_bf16_f32 v195, v38, v39
    v_pk_mul_f32 v[232:233], v[64:65], v[64:65]
    v_pk_mul_f32 v[234:235], v[66:67], v[66:67]
    v_pk_mul_f32 v[236:237], v[68:69], v[68:69]
    v_pk_mul_f32 v[238:239], v[70:71], v[70:71]
    v_pk_fma_f32 v[232:233], v[232:233], v[222:223], v[220:221]
    v_pk_fma_f32 v[234:235], v[234:235], v[222:223], v[220:221]
    v_pk_fma_f32 v[236:237], v[236:237], v[222:223], v[220:221]
    v_pk_fma_f32 v[238:239], v[238:239], v[222:223], v[220:221]
    v_pk_mul_f32 v[232:233], v[232:233], v[64:65]
    v_pk_mul_f32 v[234:235], v[234:235], v[66:67]
    v_pk_mul_f32 v[236:237], v[236:237], v[68:69]
    v_pk_mul_f32 v[238:239], v[238:239], v[70:71]
    v_pk_mul_f32 v[64:65], v[64:65], v[72:73]
    v_pk_mul_f32 v[66:67], v[66:67], v[74:75]
    v_pk_mul_f32 v[68:69], v[68:69], v[76:77]
    v_pk_mul_f32 v[70:71], v[70:71], v[78:79]
    v_pk_add_f32 v[176:177], v[176:177], v[224:225]
    v_pk_add_f32 v[178:179], v[178:179], v[224:225]
    v_pk_add_f32 v[180:181], v[180:181], v[224:225]
    v_pk_add_f32 v[182:183], v[182:183], v[224:225]
    v_rcp_f32 v176, v176
    v_rcp_f32 v177, v177
    v_rcp_f32 v178, v178
    v_rcp_f32 v179, v179
    v_rcp_f32 v180, v180
    v_rcp_f32 v181, v181
    v_rcp_f32 v182, v182
    v_rcp_f32 v183, v183
    v_exp_f32 v232, v232
    v_exp_f32 v233, v233
    v_exp_f32 v234, v234
    v_exp_f32 v235, v235
    v_exp_f32 v236, v236
    v_exp_f32 v237, v237
    v_exp_f32 v238, v238
    v_exp_f32 v239, v239
    v_pk_mul_f32 v[48:49], v[48:49], v[176:177]
    v_pk_mul_f32 v[50:51], v[50:51], v[178:179]
    v_pk_mul_f32 v[52:53], v[52:53], v[180:181]
    v_pk_mul_f32 v[54:55], v[54:55], v[182:183]
    v_cvt_pk_bf16_f32 v196, v48, v49
    v_cvt_pk_bf16_f32 v197, v50, v51
    v_cvt_pk_bf16_f32 v198, v52, v53
    v_cvt_pk_bf16_f32 v199, v54, v55
    v_pk_mul_f32 v[176:177], v[80:81], v[80:81]
    v_pk_mul_f32 v[178:179], v[82:83], v[82:83]
    v_pk_mul_f32 v[180:181], v[84:85], v[84:85]
    v_pk_mul_f32 v[182:183], v[86:87], v[86:87]
    v_pk_fma_f32 v[176:177], v[176:177], v[222:223], v[220:221]
    v_pk_fma_f32 v[178:179], v[178:179], v[222:223], v[220:221]
    v_pk_fma_f32 v[180:181], v[180:181], v[222:223], v[220:221]
    v_pk_fma_f32 v[182:183], v[182:183], v[222:223], v[220:221]
    v_pk_mul_f32 v[176:177], v[176:177], v[80:81]
    v_pk_mul_f32 v[178:179], v[178:179], v[82:83]
    v_pk_mul_f32 v[180:181], v[180:181], v[84:85]
    v_pk_mul_f32 v[182:183], v[182:183], v[86:87]
    v_pk_mul_f32 v[80:81], v[80:81], v[88:89]
    v_pk_mul_f32 v[82:83], v[82:83], v[90:91]
    v_pk_mul_f32 v[84:85], v[84:85], v[92:93]
    v_pk_mul_f32 v[86:87], v[86:87], v[94:95]
    v_pk_add_f32 v[232:233], v[232:233], v[224:225]
    v_pk_add_f32 v[234:235], v[234:235], v[224:225]
    v_pk_add_f32 v[236:237], v[236:237], v[224:225]
    v_pk_add_f32 v[238:239], v[238:239], v[224:225]
    v_rcp_f32 v232, v232
    v_rcp_f32 v233, v233
    v_rcp_f32 v234, v234
    v_rcp_f32 v235, v235
    v_rcp_f32 v236, v236
    v_rcp_f32 v237, v237
    v_rcp_f32 v238, v238
    v_rcp_f32 v239, v239
    v_exp_f32 v176, v176
    v_exp_f32 v177, v177
    v_exp_f32 v178, v178
    v_exp_f32 v179, v179
    v_exp_f32 v180, v180
    v_exp_f32 v181, v181
    v_exp_f32 v182, v182
    v_exp_f32 v183, v183
    v_pk_mul_f32 v[64:65], v[64:65], v[232:233]
    v_pk_mul_f32 v[66:67], v[66:67], v[234:235]
    v_pk_mul_f32 v[68:69], v[68:69], v[236:237]
    v_pk_mul_f32 v[70:71], v[70:71], v[238:239]
    v_cvt_pk_bf16_f32 v200, v64, v65
    v_cvt_pk_bf16_f32 v201, v66, v67
    v_cvt_pk_bf16_f32 v202, v68, v69
    v_cvt_pk_bf16_f32 v203, v70, v71
    v_pk_mul_f32 v[232:233], v[96:97], v[96:97]
    v_pk_mul_f32 v[234:235], v[98:99], v[98:99]
    v_pk_mul_f32 v[236:237], v[100:101], v[100:101]
    v_pk_mul_f32 v[238:239], v[102:103], v[102:103]
    v_pk_fma_f32 v[232:233], v[232:233], v[222:223], v[220:221]
    v_pk_fma_f32 v[234:235], v[234:235], v[222:223], v[220:221]
    v_pk_fma_f32 v[236:237], v[236:237], v[222:223], v[220:221]
    v_pk_fma_f32 v[238:239], v[238:239], v[222:223], v[220:221]
    v_pk_mul_f32 v[232:233], v[232:233], v[96:97]
    v_pk_mul_f32 v[234:235], v[234:235], v[98:99]
    v_pk_mul_f32 v[236:237], v[236:237], v[100:101]
    v_pk_mul_f32 v[238:239], v[238:239], v[102:103]
    v_pk_mul_f32 v[96:97], v[96:97], v[104:105]
    v_pk_mul_f32 v[98:99], v[98:99], v[106:107]
    v_pk_mul_f32 v[100:101], v[100:101], v[108:109]
    v_pk_mul_f32 v[102:103], v[102:103], v[110:111]
    v_pk_add_f32 v[176:177], v[176:177], v[224:225]
    v_pk_add_f32 v[178:179], v[178:179], v[224:225]
    v_pk_add_f32 v[180:181], v[180:181], v[224:225]
    v_pk_add_f32 v[182:183], v[182:183], v[224:225]
    v_rcp_f32 v176, v176
    v_rcp_f32 v177, v177
    v_rcp_f32 v178, v178
    v_rcp_f32 v179, v179
    v_rcp_f32 v180, v180
    v_rcp_f32 v181, v181
    v_rcp_f32 v182, v182
    v_rcp_f32 v183, v183
    v_exp_f32 v232, v232
    v_exp_f32 v233, v233
    v_exp_f32 v234, v234
    v_exp_f32 v235, v235
    v_exp_f32 v236, v236
    v_exp_f32 v237, v237
    v_exp_f32 v238, v238
    v_exp_f32 v239, v239
    v_pk_mul_f32 v[80:81], v[80:81], v[176:177]
    v_pk_mul_f32 v[82:83], v[82:83], v[178:179]
    v_pk_mul_f32 v[84:85], v[84:85], v[180:181]
    v_pk_mul_f32 v[86:87], v[86:87], v[182:183]
    v_cvt_pk_bf16_f32 v204, v80, v81
    v_cvt_pk_bf16_f32 v205, v82, v83
    v_cvt_pk_bf16_f32 v206, v84, v85
    v_cvt_pk_bf16_f32 v207, v86, v87
    v_pk_mul_f32 v[176:177], v[112:113], v[112:113]
    v_pk_mul_f32 v[178:179], v[114:115], v[114:115]
    v_pk_mul_f32 v[180:181], v[116:117], v[116:117]
    v_pk_mul_f32 v[182:183], v[118:119], v[118:119]
    v_pk_fma_f32 v[176:177], v[176:177], v[222:223], v[220:221]
    v_pk_fma_f32 v[178:179], v[178:179], v[222:223], v[220:221]
    v_pk_fma_f32 v[180:181], v[180:181], v[222:223], v[220:221]
    v_pk_fma_f32 v[182:183], v[182:183], v[222:223], v[220:221]
    v_pk_mul_f32 v[176:177], v[176:177], v[112:113]
    v_pk_mul_f32 v[178:179], v[178:179], v[114:115]
    v_pk_mul_f32 v[180:181], v[180:181], v[116:117]
    v_pk_mul_f32 v[182:183], v[182:183], v[118:119]
    v_pk_mul_f32 v[112:113], v[112:113], v[120:121]
    v_pk_mul_f32 v[114:115], v[114:115], v[122:123]
    v_pk_mul_f32 v[116:117], v[116:117], v[124:125]
    v_pk_mul_f32 v[118:119], v[118:119], v[126:127]
    v_pk_add_f32 v[232:233], v[232:233], v[224:225]
    v_pk_add_f32 v[234:235], v[234:235], v[224:225]
    v_pk_add_f32 v[236:237], v[236:237], v[224:225]
    v_pk_add_f32 v[238:239], v[238:239], v[224:225]
    v_rcp_f32 v232, v232
    v_rcp_f32 v233, v233
    v_rcp_f32 v234, v234
    v_rcp_f32 v235, v235
    v_rcp_f32 v236, v236
    v_rcp_f32 v237, v237
    v_rcp_f32 v238, v238
    v_rcp_f32 v239, v239
    v_exp_f32 v176, v176
    v_exp_f32 v177, v177
    v_exp_f32 v178, v178
    v_exp_f32 v179, v179
    v_exp_f32 v180, v180
    v_exp_f32 v181, v181
    v_exp_f32 v182, v182
    v_exp_f32 v183, v183
    v_pk_mul_f32 v[96:97], v[96:97], v[232:233]
    v_pk_mul_f32 v[98:99], v[98:99], v[234:235]
    v_pk_mul_f32 v[100:101], v[100:101], v[236:237]
    v_pk_mul_f32 v[102:103], v[102:103], v[238:239]
    v_cvt_pk_bf16_f32 v208, v96, v97
    v_cvt_pk_bf16_f32 v209, v98, v99
    v_cvt_pk_bf16_f32 v210, v100, v101
    v_cvt_pk_bf16_f32 v211, v102, v103
    v_pk_mul_f32 v[232:233], v[128:129], v[128:129]
    v_pk_mul_f32 v[234:235], v[130:131], v[130:131]
    v_pk_mul_f32 v[236:237], v[132:133], v[132:133]
    v_pk_mul_f32 v[238:239], v[134:135], v[134:135]
    v_pk_fma_f32 v[232:233], v[232:233], v[222:223], v[220:221]
    v_pk_fma_f32 v[234:235], v[234:235], v[222:223], v[220:221]
    v_pk_fma_f32 v[236:237], v[236:237], v[222:223], v[220:221]
    v_pk_fma_f32 v[238:239], v[238:239], v[222:223], v[220:221]
    v_pk_mul_f32 v[232:233], v[232:233], v[128:129]
    v_pk_mul_f32 v[234:235], v[234:235], v[130:131]
    v_pk_mul_f32 v[236:237], v[236:237], v[132:133]
    v_pk_mul_f32 v[238:239], v[238:239], v[134:135]
    v_pk_mul_f32 v[128:129], v[128:129], v[136:137]
    v_pk_mul_f32 v[130:131], v[130:131], v[138:139]
    v_pk_mul_f32 v[132:133], v[132:133], v[140:141]
    v_pk_mul_f32 v[134:135], v[134:135], v[142:143]
    v_pk_add_f32 v[176:177], v[176:177], v[224:225]
    v_pk_add_f32 v[178:179], v[178:179], v[224:225]
    v_pk_add_f32 v[180:181], v[180:181], v[224:225]
    v_pk_add_f32 v[182:183], v[182:183], v[224:225]
    v_rcp_f32 v176, v176
    v_rcp_f32 v177, v177
    v_rcp_f32 v178, v178
    v_rcp_f32 v179, v179
    v_rcp_f32 v180, v180
    v_rcp_f32 v181, v181
    v_rcp_f32 v182, v182
    v_rcp_f32 v183, v183
    v_exp_f32 v232, v232
    v_exp_f32 v233, v233
    v_exp_f32 v234, v234
    v_exp_f32 v235, v235
    v_exp_f32 v236, v236
    v_exp_f32 v237, v237
    v_exp_f32 v238, v238
    v_exp_f32 v239, v239
    v_pk_mul_f32 v[112:113], v[112:113], v[176:177]
    v_pk_mul_f32 v[114:115], v[114:115], v[178:179]
    v_pk_mul_f32 v[116:117], v[116:117], v[180:181]
    v_pk_mul_f32 v[118:119], v[118:119], v[182:183]
    v_cvt_pk_bf16_f32 v212, v112, v113
    v_cvt_pk_bf16_f32 v213, v114, v115
    v_cvt_pk_bf16_f32 v214, v116, v117
    v_cvt_pk_bf16_f32 v215, v118, v119
    s_nop 0
    v_pk_add_f32 v[232:233], v[232:233], v[224:225]
    v_pk_add_f32 v[234:235], v[234:235], v[224:225]
    v_pk_add_f32 v[236:237], v[236:237], v[224:225]
    v_pk_add_f32 v[238:239], v[238:239], v[224:225]
    v_rcp_f32 v232, v232
    v_rcp_f32 v233, v233
    v_rcp_f32 v234, v234
    v_rcp_f32 v235, v235
    v_rcp_f32 v236, v236
    v_rcp_f32 v237, v237
    v_rcp_f32 v238, v238
    v_rcp_f32 v239, v239
    s_nop 0
    v_pk_mul_f32 v[128:129], v[128:129], v[232:233]
    v_pk_mul_f32 v[130:131], v[130:131], v[234:235]
    v_pk_mul_f32 v[132:133], v[132:133], v[236:237]
    v_pk_mul_f32 v[134:135], v[134:135], v[238:239]
    v_cvt_pk_bf16_f32 v216, v128, v129
    v_cvt_pk_bf16_f32 v217, v130, v131
    v_cvt_pk_bf16_f32 v218, v132, v133
    v_cvt_pk_bf16_f32 v219, v134, v135
L_P2:
    s_waitcnt lgkmcnt(0)
    v_lshlrev_b32 v95, 4, v254
    v_mov_b32 v92, 0xdddd
    v_and_b32 v98, 15, v254
    v_lshlrev_b32 v98, 4, v98
    v_lshrrev_b32 v99, 5, v254
    v_lshl_or_b32 v98, v99, 8, v98
    v_add_u32 v98, 65536, v98
    v_add_u32 v99, s15, v95
    v_add_u32 v102, s16, v95
    v_and_b32 v103, 7, v254
    v_mul_u32_u24 v103, 1056, v103
    v_lshrrev_b32 v100, 3, v254
    v_lshl_add_u32 v103, v100, 4, v103
    v_add_u32 v103, s17, v103
    v_mov_b32 v93, v95
    v_mov_b32 v94, v98
    v_mov_b32 v100, 0xff800000
    v_mov_b32 v101, 0xff800000
    v_mov_b32 v104, -1
    v_mov_b32 v105, -1
    v_mov_b32 v106, -1
    v_mov_b32 v107, -1
L_P0:
    s_waitcnt vmcnt(0)
L_P0B:
    s_barrier
    ds_read_b128 v[80:83], v99
    ds_read_b128 v[84:87], v93
    ds_read_b128 v[88:91], v93 offset:1024
    s_mov_b64 exec, s[80:81]
    ds_read_b128 v[160:163], v94
    s_mov_b64 exec, -1
    s_waitcnt lgkmcnt(2)
    v_mfma_f32_32x32x16_bf16 v[0:15], v[84:87], v[80:83], 0
    s_waitcnt lgkmcnt(1)
    v_mfma_f32_32x32x16_bf16 v[32:47], v[88:91], v[80:83], 0
    s_nop 10
    v_max3_f32 v100, v0, v1, v100
    v_max3_f32 v100, v2, v3, v100
    v_max3_f32 v100, v4, v5, v100
    v_max3_f32 v100, v6, v7, v100
    v_max3_f32 v100, v8, v9, v100
    v_max3_f32 v100, v10, v11, v100
    v_max3_f32 v100, v12, v13, v100
    v_max3_f32 v100, v14, v15, v100
    v_max3_f32 v101, v32, v33, v101
    v_max3_f32 v101, v34, v35, v101
    v_max3_f32 v101, v36, v37, v101
    v_max3_f32 v101, v38, v39, v101
    v_max3_f32 v101, v40, v41, v101
    v_max3_f32 v101, v42, v43, v101
    v_max3_f32 v101, v44, v45, v101
    v_max3_f32 v101, v46, v47, v101
    v_max_f32 v100, v100, v101
    v_mov_b32 v101, v100
    s_nop 1
    v_permlane32_swap_b32 v100, v101
    s_nop 1
    v_max_f32 v100, v100, v101
    v_sub_f32 v32, s79, v100
    v_sub_f32 v33, s79, v100
    v_sub_f32 v34, s79, v100
    v_sub_f32 v35, s79, v100
    v_sub_f32 v36, s79, v100
    v_sub_f32 v37, s79, v100
    v_sub_f32 v38, s79, v100
    v_sub_f32 v39, s79, v100
    v_sub_f32 v40, s79, v100
    v_sub_f32 v41, s79, v100
    v_sub_f32 v42, s79, v100
    v_sub_f32 v43, s79, v100
    v_sub_f32 v44, s79, v100
    v_sub_f32 v45, s79, v100
    v_sub_f32 v46, s79, v100
    v_sub_f32 v47, s79, v100
    s_nop 1
    v_mfma_f32_32x32x16_bf16 v[0:15], v[84:87], v[80:83], v[32:47]
    ds_read_b128 v[84:87], v93 offset:2048
    s_mov_b64 exec, s[80:81]
    ds_read_b128 v[164:167], v94 offset:1024
    ds_read_b128 v[168:171], v94 offset:512
    s_mov_b64 exec, -1
    s_mov_b32 s83, 0
    s_nop 4
    s_setprio 3
    s_waitcnt lgkmcnt(3)
    v_exp_f32 v0, v0
    v_exp_f32 v1, v1
    v_exp_f32 v2, v2
    v_exp_f32 v3, v3
    v_exp_f32 v4, v4
    v_exp_f32 v5, v5
    v_exp_f32 v6, v6
    v_mfma_f32_32x32x16_bf16 v[16:31], v[88:91], v[80:83], v[32:47]
    ds_read_b128 v[88:91], v93 offset:3072
    v_exp_f32 v7, v7
    v_exp_f32 v8, v8
    v_exp_f32 v9, v9
    v_exp_f32 v10, v10
    v_exp_f32 v11, v11
    v_smfmac_f32_32x32x32_bf16 v[144:159], v[160:163], v[0:7], v92
    s_mov_b64 exec, s[80:81]
    ds_read_b128 v[160:163], v94 offset:2048
    ds_read_b128 v[172:175], v94 offset:1536
    s_mov_b64 exec, -1
    buffer_store_dwordx4 v[184:187], v249, s[32:35], s52 offen sc1
    v_exp_f32 v12, v12
    v_exp_f32 v13, v13
    v_exp_f32 v14, v14
    v_exp_f32 v15, v15
    s_waitcnt lgkmcnt(3)
    v_exp_f32 v16, v16
    v_exp_f32 v17, v17
    v_smfmac_f32_32x32x32_bf16 v[144:159], v[168:171], v[8:15], v92
    s_mov_b32 m0, s95
    s_add_u32 s60, s94, 0x200000
    buffer_load_dwordx4 v95, s[32:35], s94 offen sc1 lds
    v_exp_f32 v18, v18
    v_exp_f32 v19, v19
    v_exp_f32 v20, v20
    v_exp_f32 v21, v21
    v_exp_f32 v22, v22
    v_mfma_f32_32x32x16_bf16 v[0:15], v[84:87], v[80:83], v[32:47]
    ds_read_b128 v[84:87], v93 offset:4096
    s_add_u32 m0, s95, 65536
    s_add_u32 s94, s94, 8192
    buffer_load_dwordx4 v95, s[32:35], s60 offen sc1 lds
    s_add_u32 s95, s95, 8192
    v_exp_f32 v23, v23
    v_exp_f32 v24, v24
    v_exp_f32 v25, v25
    v_exp_f32 v26, v26
    v_exp_f32 v27, v27
    v_smfmac_f32_32x32x32_bf16 v[144:159], v[164:167], v[16:23], v92
    s_mov_b64 exec, s[80:81]
    ds_read_b128 v[164:167], v94 offset:3072
    ds_read_b128 v[168:171], v94 offset:2560
    s_mov_b64 exec, -1
    buffer_store_dwordx4 v[188:191], v249, s[32:35], s53 offen sc1
    v_exp_f32 v28, v28
    v_exp_f32 v29, v29
    v_exp_f32 v30, v30
    v_exp_f32 v31, v31
    s_setprio 2
    s_waitcnt lgkmcnt(3)
    v_exp_f32 v0, v0
    v_exp_f32 v1, v1
    v_smfmac_f32_32x32x32_bf16 v[144:159], v[172:175], v[24:31], v92
    v_exp_f32 v2, v2
    v_exp_f32 v3, v3
    v_exp_f32 v4, v4
    v_exp_f32 v5, v5
    v_exp_f32 v6, v6
    v_mfma_f32_32x32x16_bf16 v[16:31], v[88:91], v[80:83], v[32:47]
    ds_read_b128 v[88:91], v93 offset:5120
    v_exp_f32 v7, v7
    v_exp_f32 v8, v8
    v_exp_f32 v9, v9
    v_exp_f32 v10, v10
    v_exp_f32 v11, v11
    v_smfmac_f32_32x32x32_bf16 v[144:159], v[160:163], v[0:7], v92
    s_mov_b64 exec, s[80:81]
    ds_read_b128 v[160:163], v94 offset:4096
    ds_read_b128 v[172:175], v94 offset:3584
    s_mov_b64 exec, -1
    buffer_store_dwordx4 v[192:195], v249, s[32:35], s54 offen sc1
    v_exp_f32 v12, v12
    v_exp_f32 v13, v13
    v_exp_f32 v14, v14
    v_exp_f32 v15, v15
    s_waitcnt lgkmcnt(3)
    v_exp_f32 v16, v16
    v_exp_f32 v17, v17
    v_smfmac_f32_32x32x32_bf16 v[144:159], v[168:171], v[8:15], v92
    v_exp_f32 v18, v18
    v_exp_f32 v19, v19
    v_exp_f32 v20, v20
    v_exp_f32 v21, v21
    v_exp_f32 v22, v22
    v_mfma_f32_32x32x16_bf16 v[0:15], v[84:87], v[80:83], v[32:47]
    ds_read_b128 v[84:87], v93 offset:6144
    v_exp_f32 v23, v23
    v_exp_f32 v24, v24
    v_exp_f32 v25, v25
    v_exp_f32 v26, v26
    v_exp_f32 v27, v27
    v_smfmac_f32_32x32x32_bf16 v[144:159], v[164:167], v[16:23], v92
    s_mov_b64 exec, s[80:81]
    ds_read_b128 v[164:167], v94 offset:5120
    ds_read_b128 v[168:171], v94 offset:4608
    s_mov_b64 exec, -1
    buffer_store_dwordx4 v[196:199], v249, s[32:35], s55 offen sc1
    v_exp_f32 v28, v28
    v_exp_f32 v29, v29
    v_exp_f32 v30, v30
    v_exp_f32 v31, v31
    s_setprio 1
    s_waitcnt lgkmcnt(3)
    v_exp_f32 v0, v0
    v_exp_f32 v1, v1
    v_smfmac_f32_32x32x32_bf16 v[144:159], v[172:175], v[24:31], v92
    s_mov_b32 m0, s95
    s_add_u32 s60, s94, 0x200000
    buffer_load_dwordx4 v95, s[32:35], s94 offen sc1 lds
    v_exp_f32 v2, v2
    v_exp_f32 v3, v3
    v_exp_f32 v4, v4
    v_exp_f32 v5, v5
    v_exp_f32 v6, v6
    v_mfma_f32_32x32x16_bf16 v[16:31], v[88:91], v[80:83], v[32:47]
    ds_read_b128 v[88:91], v93 offset:7168
    s_add_u32 m0, s95, 65536
    s_add_u32 s94, s94, 8192
    buffer_load_dwordx4 v95, s[32:35], s60 offen sc1 lds
    s_add_u32 s95, s95, 8192
    v_exp_f32 v7, v7
    v_exp_f32 v8, v8
    v_exp_f32 v9, v9
    v_exp_f32 v10, v10
    v_exp_f32 v11, v11
    v_smfmac_f32_32x32x32_bf16 v[144:159], v[160:163], v[0:7], v92
    s_mov_b64 exec, s[80:81]
    ds_read_b128 v[160:163], v94 offset:6144
    ds_read_b128 v[172:175], v94 offset:5632
    s_mov_b64 exec, -1
    buffer_store_dwordx4 v[200:203], v249, s[32:35], s56 offen sc1
    v_exp_f32 v12, v12
    v_exp_f32 v13, v13
    v_exp_f32 v14, v14
    v_exp_f32 v15, v15
    s_waitcnt lgkmcnt(3)
    v_exp_f32 v16, v16
    v_exp_f32 v17, v17
    v_smfmac_f32_32x32x32_bf16 v[144:159], v[168:171], v[8:15], v92
    v_exp_f32 v18, v18
    v_exp_f32 v19, v19
    v_exp_f32 v20, v20
    v_exp_f32 v21, v21
    v_exp_f32 v22, v22
    v_mfma_f32_32x32x16_bf16 v[0:15], v[84:87], v[80:83], v[32:47]
    ds_read_b128 v[84:87], v93 offset:8192
    v_exp_f32 v23, v23
    v_exp_f32 v24, v24
    v_exp_f32 v25, v25
    v_exp_f32 v26, v26
    v_exp_f32 v27, v27
    v_smfmac_f32_32x32x32_bf16 v[144:159], v[164:167], v[16:23], v92
    s_mov_b64 exec, s[80:81]
    ds_read_b128 v[164:167], v94 offset:7168
    ds_read_b128 v[168:171], v94 offset:6656
    s_mov_b64 exec, -1
    buffer_store_dwordx4 v[204:207], v249, s[32:35], s57 offen sc1
    v_exp_f32 v28, v28
    v_exp_f32 v29, v29
    v_exp_f32 v30, v30
    v_exp_f32 v31, v31
    s_setprio 0
    s_waitcnt lgkmcnt(3)
    v_exp_f32 v0, v0
    v_exp_f32 v1, v1
    v_smfmac_f32_32x32x32_bf16 v[144:159], v[172:175], v[24:31], v92
    v_exp_f32 v2, v2
    v_exp_f32 v3, v3
    v_exp_f32 v4, v4
    v_exp_f32 v5, v5
    v_exp_f32 v6, v6
    v_mfma_f32_32x32x16_bf16 v[16:31], v[88:91], v[80:83], v[32:47]
    ds_read_b128 v[88:91], v93 offset:9216
    v_exp_f32 v7, v7
    v_exp_f32 v8, v8
    v_exp_f32 v9, v9
    v_exp_f32 v10, v10
    v_exp_f32 v11, v11
    v_smfmac_f32_32x32x32_bf16 v[144:159], v[160:163], v[0:7], v92
    s_mov_b64 exec, s[80:81]
    ds_read_b128 v[160:163], v94 offset:8192
    ds_read_b128 v[172:175], v94 offset:7680
    s_mov_b64 exec, -1
    buffer_store_dwordx4 v[208:211], v249, s[32:35], s58 offen sc1
    buffer_store_dwordx4 v[212:215], v249, s[32:35], s59 offen sc1
    v_exp_f32 v12, v12
    v_exp_f32 v13, v13
    v_exp_f32 v14, v14
    v_exp_f32 v15, v15
    s_waitcnt lgkmcnt(3)
    v_exp_f32 v16, v16
    v_exp_f32 v17, v17
    v_smfmac_f32_32x32x32_bf16 v[144:159], v[168:171], v[8:15], v92
    v_exp_f32 v18, v18
    v_exp_f32 v19, v19
    v_exp_f32 v20, v20
    v_exp_f32 v21, v21
    v_exp_f32 v22, v22
    v_mfma_f32_32x32x16_bf16 v[0:15], v[84:87], v[80:83], v[32:47]
    ds_read_b128 v[84:87], v93 offset:10240
    v_exp_f32 v23, v23
    v_exp_f32 v24, v24
    v_exp_f32 v25, v25
    v_exp_f32 v26, v26
    v_exp_f32 v27, v27
    v_smfmac_f32_32x32x32_bf16 v[144:159], v[164:167], v[16:23], v92
    s_mov_b64 exec, s[80:81]
    ds_read_b128 v[164:167], v94 offset:9216
    ds_read_b128 v[168:171], v94 offset:8704
    s_mov_b64 exec, -1
    buffer_store_dwordx4 v[104:107], v95, s[32:35], s11 offen sc1
    buffer_store_dwordx4 v[216:219], v249, s[32:35], s10 offen sc1
    v_exp_f32 v28, v28
    v_exp_f32 v29, v29
    v_exp_f32 v30, v30
    v_exp_f32 v31, v31
    v_add_u32 v93, 8192, v93
    v_add_u32 v94, 8192, v94
    s_add_u32 s83, s83, 1
L_BODY1:
    s_setprio 3
    s_waitcnt lgkmcnt(3)
    v_exp_f32 v0, v0
    v_exp_f32 v1, v1
    v_smfmac_f32_32x32x32_bf16 v[144:159], v[172:175], v[24:31], v92
    v_exp_f32 v2, v2
    v_exp_f32 v3, v3
    v_exp_f32 v4, v4
    v_exp_f32 v5, v5
    v_exp_f32 v6, v6
    v_mfma_f32_32x32x16_bf16 v[16:31], v[88:91], v[80:83], v[32:47]
    ds_read_b128 v[88:91], v93 offset:3072
    v_exp_f32 v7, v7
    v_exp_f32 v8, v8
    v_exp_f32 v9, v9
    v_exp_f32 v10, v10
    v_exp_f32 v11, v11
    v_smfmac_f32_32x32x32_bf16 v[144:159], v[160:163], v[0:7], v92
    s_mov_b64 exec, s[80:81]
    ds_read_b128 v[160:163], v94 offset:2048
    ds_read_b128 v[172:175], v94 offset:1536
    s_mov_b64 exec, -1
    v_exp_f32 v12, v12
    v_exp_f32 v13, v13
    v_exp_f32 v14, v14
    v_exp_f32 v15, v15
    s_waitcnt lgkmcnt(3)
    v_exp_f32 v16, v16
    v_exp_f32 v17, v17
    v_smfmac_f32_32x32x32_bf16 v[144:159], v[168:171], v[8:15], v92
    v_exp_f32 v18, v18
    v_exp_f32 v19, v19
    v_exp_f32 v20, v20
    v_exp_f32 v21, v21
    v_exp_f32 v22, v22
    v_mfma_f32_32x32x16_bf16 v[0:15], v[84:87], v[80:83], v[32:47]
    ds_read_b128 v[84:87], v93 offset:4096
    v_exp_f32 v23, v23
    v_exp_f32 v24, v24
    v_exp_f32 v25, v25
    v_exp_f32 v26, v26
    v_exp_f32 v27, v27
    v_smfmac_f32_32x32x32_bf16 v[144:159], v[164:167], v[16:23], v92
    s_mov_b64 exec, s[80:81]
    ds_read_b128 v[164:167], v94 offset:3072
    ds_read_b128 v[168:171], v94 offset:2560
    s_mov_b64 exec, -1
    v_exp_f32 v28, v28
    v_exp_f32 v29, v29
    v_exp_f32 v30, v30
    v_exp_f32 v31, v31
    s_waitcnt vmcnt(0)
    s_barrier
    s_cmp_lg_u32 s22, 0
    s_cbranch_scc1 L_NOSIG
    s_mov_b64 exec, 0xff
    v_mov_b32 v97, 1
    v_lshlrev_b32 v96, 10, v254
    buffer_atomic_add v97, v96, s[32:35], s91 offen
    s_mov_b64 exec, -1
L_NOSIG:
    s_setprio 2
    s_waitcnt lgkmcnt(3)
    v_exp_f32 v0, v0
    v_exp_f32 v1, v1
    v_smfmac_f32_32x32x32_bf16 v[144:159], v[172:175], v[24:31], v92
    s_mov_b32 m0, s95
    s_add_u32 s60, s94, 0x200000
    buffer_load_dwordx4 v95, s[32:35], s94 offen sc1 lds
    v_exp_f32 v2, v2
    v_exp_f32 v3, v3
    v_exp_f32 v4, v4
    v_exp_f32 v5, v5
    v_exp_f32 v6, v6
    v_mfma_f32_32x32x16_bf16 v[16:31], v[88:91], v[80:83], v[32:47]
    ds_read_b128 v[88:91], v93 offset:5120
    s_add_u32 m0, s95, 65536
    s_add_u32 s94, s94, 8192
    buffer_load_dwordx4 v95, s[32:35], s60 offen sc1 lds
    s_add_u32 s95, s95, 8192
    v_exp_f32 v7, v7
    v_exp_f32 v8, v8
    v_exp_f32 v9, v9
    v_exp_f32 v10, v10
    v_exp_f32 v11, v11
    v_smfmac_f32_32x32x32_bf16 v[144:159], v[160:163], v[0:7], v92
    s_mov_b64 exec, s[80:81]
    ds_read_b128 v[160:163], v94 offset:4096
    ds_read_b128 v[172:175], v94 offset:3584
    s_mov_b64 exec, -1
    v_exp_f32 v12, v12
    v_exp_f32 v13, v13
    v_exp_f32 v14, v14
    v_exp_f32 v15, v15
    s_waitcnt lgkmcnt(3)
    v_exp_f32 v16, v16
    v_exp_f32 v17, v17
    v_smfmac_f32_32x32x32_bf16 v[144:159], v[168:171], v[8:15], v92
    s_mov_b32 m0, s95
    s_add_u32 s60, s94, 0x200000
    buffer_load_dwordx4 v95, s[32:35], s94 offen sc1 lds
    v_exp_f32 v18, v18
    v_exp_f32 v19, v19
    v_exp_f32 v20, v20
    v_exp_f32 v21, v21
    v_exp_f32 v22, v22
    v_mfma_f32_32x32x16_bf16 v[0:15], v[84:87], v[80:83], v[32:47]
    ds_read_b128 v[84:87], v93 offset:6144
    s_add_u32 m0, s95, 65536
    s_add_u32 s94, s94, 8192
    buffer_load_dwordx4 v95, s[32:35], s60 offen sc1 lds
    s_add_u32 s95, s95, 8192
    v_exp_f32 v23, v23
    v_exp_f32 v24, v24
    v_exp_f32 v25, v25
    v_exp_f32 v26, v26
    v_exp_f32 v27, v27
    v_smfmac_f32_32x32x32_bf16 v[144:159], v[164:167], v[16:23], v92
    s_mov_b64 exec, s[80:81]
    ds_read_b128 v[164:167], v94 offset:5120
    ds_read_b128 v[168:171], v94 offset:4608
    s_mov_b64 exec, -1
    v_exp_f32 v28, v28
    v_exp_f32 v29, v29
    v_exp_f32 v30, v30
    v_exp_f32 v31, v31
    s_setprio 1
    s_waitcnt lgkmcnt(3)
    v_exp_f32 v0, v0
    v_exp_f32 v1, v1
    v_smfmac_f32_32x32x32_bf16 v[144:159], v[172:175], v[24:31], v92
    s_mov_b32 m0, s95
    s_add_u32 s60, s94, 0x200000
    buffer_load_dwordx4 v95, s[32:35], s94 offen sc1 lds
    v_exp_f32 v2, v2
    v_exp_f32 v3, v3
    v_exp_f32 v4, v4
    v_exp_f32 v5, v5
    v_exp_f32 v6, v6
    v_mfma_f32_32x32x16_bf16 v[16:31], v[88:91], v[80:83], v[32:47]
    ds_read_b128 v[88:91], v93 offset:7168
    s_add_u32 m0, s95, 65536
    s_add_u32 s94, s94, 8192
    buffer_load_dwordx4 v95, s[32:35], s60 offen sc1 lds
    s_add_u32 s95, s95, 8192
    v_exp_f32 v7, v7
    v_exp_f32 v8, v8
    v_exp_f32 v9, v9
    v_exp_f32 v10, v10
    v_exp_f32 v11, v11
    v_smfmac_f32_32x32x32_bf16 v[144:159], v[160:163], v[0:7], v92
    s_mov_b64 exec, s[80:81]
    ds_read_b128 v[160:163], v94 offset:6144
    ds_read_b128 v[172:175], v94 offset:5632
    s_mov_b64 exec, -1
    v_exp_f32 v12, v12
    v_exp_f32 v13, v13
    v_exp_f32 v14, v14
    v_exp_f32 v15, v15
    s_waitcnt lgkmcnt(3)
    v_exp_f32 v16, v16
    v_exp_f32 v17, v17
    v_smfmac_f32_32x32x32_bf16 v[144:159], v[168:171], v[8:15], v92
    s_mov_b32 m0, s95
    s_add_u32 s60, s94, 0x200000
    buffer_load_dwordx4 v95, s[32:35], s94 offen sc1 lds
    v_exp_f32 v18, v18
    v_exp_f32 v19, v19
    v_exp_f32 v20, v20
    v_exp_f32 v21, v21
    v_exp_f32 v22, v22
    v_mfma_f32_32x32x16_bf16 v[0:15], v[84:87], v[80:83], v[32:47]
    ds_read_b128 v[84:87], v93 offset:8192
    s_add_u32 m0, s95, 65536
    s_add_u32 s94, s94, 8192
    buffer_load_dwordx4 v95, s[32:35], s60 offen sc1 lds
    s_add_u32 s95, s95, 8192
    v_exp_f32 v23, v23
    v_exp_f32 v24, v24
    v_exp_f32 v25, v25
    v_exp_f32 v26, v26
    v_exp_f32 v27, v27
    v_smfmac_f32_32x32x32_bf16 v[144:159], v[164:167], v[16:23], v92
    s_mov_b64 exec, s[80:81]
    ds_read_b128 v[164:167], v94 offset:7168
    ds_read_b128 v[168:171], v94 offset:6656
    s_mov_b64 exec, -1
    v_exp_f32 v28, v28
    v_exp_f32 v29, v29
    v_exp_f32 v30, v30
    v_exp_f32 v31, v31
    s_setprio 0
    s_waitcnt lgkmcnt(3)
    v_exp_f32 v0, v0
    v_exp_f32 v1, v1
    v_smfmac_f32_32x32x32_bf16 v[144:159], v[172:175], v[24:31], v92
    v_exp_f32 v2, v2
    v_exp_f32 v3, v3
    v_exp_f32 v4, v4
    v_exp_f32 v5, v5
    v_exp_f32 v6, v6
    v_mfma_f32_32x32x16_bf16 v[16:31], v[88:91], v[80:83], v[32:47]
    ds_read_b128 v[88:91], v93 offset:9216
    v_exp_f32 v7, v7
    v_exp_f32 v8, v8
    v_exp_f32 v9, v9
    v_exp_f32 v10, v10
    v_exp_f32 v11, v11
    v_smfmac_f32_32x32x32_bf16 v[144:159], v[160:163], v[0:7], v92
    s_mov_b64 exec, s[80:81]
    ds_read_b128 v[160:163], v94 offset:8192
    ds_read_b128 v[172:175], v94 offset:7680
    s_mov_b64 exec, -1
    v_exp_f32 v12, v12
    v_exp_f32 v13, v13
    v_exp_f32 v14, v14
    v_exp_f32 v15, v15
    s_cmp_lg_u32 s22, 0
    s_cbranch_scc1 L_NOPQ
    v_lshlrev_b32 v100, 7, v254
    v_mov_b32 v101, 0
    s_mov_b64 exec, 15
    buffer_atomic_add v101, v100, s[32:35], s75 offen sc0
    s_mov_b64 exec, -1
L_NOPQ:
    s_waitcnt lgkmcnt(3)
    v_exp_f32 v16, v16
    v_exp_f32 v17, v17
    v_smfmac_f32_32x32x32_bf16 v[144:159], v[168:171], v[8:15], v92
    v_exp_f32 v18, v18
    v_exp_f32 v19, v19
    v_exp_f32 v20, v20
    v_exp_f32 v21, v21
    v_exp_f32 v22, v22
    v_mfma_f32_32x32x16_bf16 v[0:15], v[84:87], v[80:83], v[32:47]
    ds_read_b128 v[84:87], v93 offset:10240
    v_exp_f32 v23, v23
    v_exp_f32 v24, v24
    v_exp_f32 v25, v25
    v_exp_f32 v26, v26
    v_exp_f32 v27, v27
    v_smfmac_f32_32x32x32_bf16 v[144:159], v[164:167], v[16:23], v92
    s_mov_b64 exec, s[80:81]
    ds_read_b128 v[164:167], v94 offset:9216
    ds_read_b128 v[168:171], v94 offset:8704
    s_mov_b64 exec, -1
    v_exp_f32 v28, v28
    v_exp_f32 v29, v29
    v_exp_f32 v30, v30
    v_exp_f32 v31, v31
    s_cmp_lg_u32 s22, 0
    s_cbranch_scc1 L_HPOLL_OK
    s_mov_b32 s70, 20000
L_HPOLL2:
    s_waitcnt vmcnt(0)
    v_cmp_eq_u32 vcc, 64, v101
    s_cmp_eq_u64 vcc, 15
    s_cbranch_scc1 L_HPOLL2_OK
    s_sleep 2
    v_mov_b32 v101, 0
    s_mov_b64 exec, 15
    buffer_atomic_add v101, v100, s[32:35], s75 offen sc0
    s_mov_b64 exec, -1
    s_sub_u32 s70, s70, 1
    s_cmp_lg_u32 s70, 0
    s_cbranch_scc1 L_HPOLL2
L_HPOLL2_OK:
L_HPOLL_OK:
    s_waitcnt vmcnt(0)
    s_barrier
    v_add_u32 v93, 8192, v93
    v_add_u32 v94, 8192, v94
    s_add_u32 s83, s83, 1
    s_setprio 3
    s_waitcnt lgkmcnt(3)
    v_exp_f32 v0, v0
    v_exp_f32 v1, v1
    v_smfmac_f32_32x32x32_bf16 v[144:159], v[172:175], v[24:31], v92
    v_exp_f32 v2, v2
    v_exp_f32 v3, v3
    v_exp_f32 v4, v4
    v_exp_f32 v5, v5
    v_exp_f32 v6, v6
    v_mfma_f32_32x32x16_bf16 v[16:31], v[88:91], v[80:83], v[32:47]
    ds_read_b128 v[88:91], v93 offset:3072
    v_exp_f32 v7, v7
    v_exp_f32 v8, v8
    v_exp_f32 v9, v9
    v_exp_f32 v10, v10
    v_exp_f32 v11, v11
    v_smfmac_f32_32x32x32_bf16 v[144:159], v[160:163], v[0:7], v92
    s_mov_b64 exec, s[80:81]
    ds_read_b128 v[160:163], v94 offset:2048
    ds_read_b128 v[172:175], v94 offset:1536
    s_mov_b64 exec, -1
    buffer_load_dwordx4 v[128:131], v95, s[44:47], s84 offen sc1
    buffer_load_dwordx4 v[132:135], v95, s[48:51], s85 offen sc1
    buffer_load_dwordx4 v[136:139], v95, s[48:51], s85 offen offset:1024 sc1
    s_add_u32 s84, s84, 1024
    s_add_u32 s85, s85, 2048
    v_exp_f32 v12, v12
    v_exp_f32 v13, v13
    v_exp_f32 v14, v14
    v_exp_f32 v15, v15
    s_waitcnt lgkmcnt(3)
    v_exp_f32 v16, v16
    v_exp_f32 v17, v17
    v_smfmac_f32_32x32x32_bf16 v[144:159], v[168:171], v[8:15], v92
    v_exp_f32 v18, v18
    v_exp_f32 v19, v19
    v_exp_f32 v20, v20
    v_exp_f32 v21, v21
    v_exp_f32 v22, v22
    v_mfma_f32_32x32x16_bf16 v[0:15], v[84:87], v[80:83], v[32:47]
    ds_read_b128 v[84:87], v93 offset:4096
    v_exp_f32 v23, v23
    v_exp_f32 v24, v24
    v_exp_f32 v25, v25
    v_exp_f32 v26, v26
    v_exp_f32 v27, v27
    v_smfmac_f32_32x32x32_bf16 v[144:159], v[164:167], v[16:23], v92
    s_mov_b64 exec, s[80:81]
    ds_read_b128 v[164:167], v94 offset:3072
    ds_read_b128 v[168:171], v94 offset:2560
    s_mov_b64 exec, -1
    buffer_load_dwordx4 v[140:143], v95, s[44:47], s84 offen sc1
    buffer_load_dwordx4 v[176:179], v95, s[48:51], s85 offen sc1
    buffer_load_dwordx4 v[180:183], v95, s[48:51], s85 offen offset:1024 sc1
    s_add_u32 s84, s84, 1024
    s_add_u32 s85, s85, 2048
    v_exp_f32 v28, v28
    v_exp_f32 v29, v29
    v_exp_f32 v30, v30
    v_exp_f32 v31, v31
    s_setprio 2
    s_waitcnt lgkmcnt(3)
    v_exp_f32 v0, v0
    v_exp_f32 v1, v1
    v_smfmac_f32_32x32x32_bf16 v[144:159], v[172:175], v[24:31], v92
    v_exp_f32 v2, v2
    v_exp_f32 v3, v3
    v_exp_f32 v4, v4
    v_exp_f32 v5, v5
    v_exp_f32 v6, v6
    v_mfma_f32_32x32x16_bf16 v[16:31], v[88:91], v[80:83], v[32:47]
    ds_read_b128 v[88:91], v93 offset:5120
    v_exp_f32 v7, v7
    v_exp_f32 v8, v8
    v_exp_f32 v9, v9
    v_exp_f32 v10, v10
    v_exp_f32 v11, v11
    v_smfmac_f32_32x32x32_bf16 v[144:159], v[160:163], v[0:7], v92
    s_mov_b64 exec, s[80:81]
    ds_read_b128 v[160:163], v94 offset:4096
    ds_read_b128 v[172:175], v94 offset:3584
    s_mov_b64 exec, -1
    buffer_load_dwordx4 v[104:107], v95, s[44:47], s84 offen sc1
    buffer_load_dwordx4 v[108:111], v95, s[48:51], s85 offen sc1
    buffer_load_dwordx4 v[112:115], v95, s[48:51], s85 offen offset:1024 sc1
    s_add_u32 s84, s84, 1024
    s_add_u32 s85, s85, 2048
    v_exp_f32 v12, v12
    v_exp_f32 v13, v13
    v_exp_f32 v14, v14
    v_exp_f32 v15, v15
    s_waitcnt lgkmcnt(3)
    v_exp_f32 v16, v16
    v_exp_f32 v17, v17
    v_smfmac_f32_32x32x32_bf16 v[144:159], v[168:171], v[8:15], v92
    v_exp_f32 v18, v18
    v_exp_f32 v19, v19
    v_exp_f32 v20, v20
    v_exp_f32 v21, v21
    v_exp_f32 v22, v22
    v_mfma_f32_32x32x16_bf16 v[0:15], v[84:87], v[80:83], v[32:47]
    ds_read_b128 v[84:87], v93 offset:6144
    v_exp_f32 v23, v23
    v_exp_f32 v24, v24
    v_exp_f32 v25, v25
    v_exp_f32 v26, v26
    v_exp_f32 v27, v27
    v_smfmac_f32_32x32x32_bf16 v[144:159], v[164:167], v[16:23], v92
    s_mov_b64 exec, s[80:81]
    ds_read_b128 v[164:167], v94 offset:5120
    ds_read_b128 v[168:171], v94 offset:4608
    s_mov_b64 exec, -1
    buffer_load_dwordx4 v[116:119], v95, s[44:47], s84 offen sc1
    buffer_load_dwordx4 v[120:123], v95, s[48:51], s85 offen sc1
    buffer_load_dwordx4 v[124:127], v95, s[48:51], s85 offen offset:1024 sc1
    s_add_u32 s84, s84, 1024
    s_add_u32 s85, s85, 2048
    v_exp_f32 v28, v28
    v_exp_f32 v29, v29
    v_exp_f32 v30, v30
    v_exp_f32 v31, v31
    s_setprio 1
    s_waitcnt lgkmcnt(3)
    v_exp_f32 v0, v0
    v_exp_f32 v1, v1
    v_smfmac_f32_32x32x32_bf16 v[144:159], v[172:175], v[24:31], v92
    v_exp_f32 v2, v2
    v_exp_f32 v3, v3
    v_exp_f32 v4, v4
    v_exp_f32 v5, v5
    v_mfma_f32_32x32x16_bf16 v[16:31], v[88:91], v[80:83], v[32:47]
    ds_read_b128 v[88:91], v93 offset:7168
    v_exp_f32 v6, v6
    v_exp_f32 v7, v7
    v_exp_f32 v8, v8
    v_exp_f32 v9, v9
    v_smfmac_f32_32x32x32_bf16 v[144:159], v[160:163], v[0:7], v92
    s_mov_b64 exec, s[80:81]
    ds_read_b128 v[160:163], v94 offset:6144
    ds_read_b128 v[172:175], v94 offset:5632
    s_mov_b64 exec, -1
    v_exp_f32 v10, v10
    v_exp_f32 v11, v11
    v_exp_f32 v12, v12
    v_exp_f32 v13, v13
    s_waitcnt vmcnt(9)
    v_mfma_f32_32x32x16_bf16 v[48:63], v[132:135], v[128:131], 0
    v_exp_f32 v14, v14
    v_exp_f32 v15, v15
    s_waitcnt lgkmcnt(3)
    v_exp_f32 v16, v16
    v_exp_f32 v17, v17
    v_smfmac_f32_32x32x32_bf16 v[144:159], v[168:171], v[8:15], v92
    v_exp_f32 v18, v18
    v_exp_f32 v19, v19
    v_exp_f32 v20, v20
    v_exp_f32 v21, v21
    v_mfma_f32_32x32x16_bf16 v[0:15], v[84:87], v[80:83], v[32:47]
    ds_read_b128 v[84:87], v93 offset:8192
    v_exp_f32 v22, v22
    v_exp_f32 v23, v23
    v_exp_f32 v24, v24
    v_exp_f32 v25, v25
    v_smfmac_f32_32x32x32_bf16 v[144:159], v[164:167], v[16:23], v92
    s_mov_b64 exec, s[80:81]
    ds_read_b128 v[164:167], v94 offset:7168
    ds_read_b128 v[168:171], v94 offset:6656
    s_mov_b64 exec, -1
    v_exp_f32 v26, v26
    v_exp_f32 v27, v27
    v_exp_f32 v28, v28
    v_exp_f32 v29, v29
    v_mfma_f32_32x32x16_bf16 v[64:79], v[136:139], v[128:131], 0
    buffer_load_dwordx4 v[128:131], v95, s[44:47], s84 offen sc1
    buffer_load_dwordx4 v[132:135], v95, s[48:51], s85 offen sc1
    buffer_load_dwordx4 v[136:139], v95, s[48:51], s85 offen offset:1024 sc1
    s_add_u32 s84, s84, 1024
    s_add_u32 s85, s85, 2048
    v_exp_f32 v30, v30
    v_exp_f32 v31, v31
    s_setprio 0
    s_waitcnt lgkmcnt(3)
    v_exp_f32 v0, v0
    v_exp_f32 v1, v1
    v_smfmac_f32_32x32x32_bf16 v[144:159], v[172:175], v[24:31], v92
    v_exp_f32 v2, v2
    v_exp_f32 v3, v3
    v_exp_f32 v4, v4
    v_exp_f32 v5, v5
    v_mfma_f32_32x32x16_bf16 v[16:31], v[88:91], v[80:83], v[32:47]
    ds_read_b128 v[88:91], v93 offset:9216
    v_exp_f32 v6, v6
    v_exp_f32 v7, v7
    v_exp_f32 v8, v8
    v_exp_f32 v9, v9
    v_smfmac_f32_32x32x32_bf16 v[144:159], v[160:163], v[0:7], v92
    s_mov_b64 exec, s[80:81]
    ds_read_b128 v[160:163], v94 offset:8192
    ds_read_b128 v[172:175], v94 offset:7680
    s_mov_b64 exec, -1
    v_exp_f32 v10, v10
    v_exp_f32 v11, v11
    v_exp_f32 v12, v12
    v_exp_f32 v13, v13
    s_waitcnt vmcnt(9)
    v_mfma_f32_32x32x16_bf16 v[48:63], v[176:179], v[140:143], v[48:63]
    v_exp_f32 v14, v14
    v_exp_f32 v15, v15
    s_waitcnt lgkmcnt(3)
    v_exp_f32 v16, v16
    v_exp_f32 v17, v17
    v_smfmac_f32_32x32x32_bf16 v[144:159], v[168:171], v[8:15], v92
    v_exp_f32 v18, v18
    v_exp_f32 v19, v19
    v_exp_f32 v20, v20
    v_exp_f32 v21, v21
    v_mfma_f32_32x32x16_bf16 v[0:15], v[84:87], v[80:83], v[32:47]
    ds_read_b128 v[84:87], v93 offset:10240
    v_exp_f32 v22, v22
    v_exp_f32 v23, v23
    v_exp_f32 v24, v24
    v_exp_f32 v25, v25
    v_smfmac_f32_32x32x32_bf16 v[144:159], v[164:167], v[16:23], v92
    s_mov_b64 exec, s[80:81]
    ds_read_b128 v[164:167], v94 offset:9216
    ds_read_b128 v[168:171], v94 offset:8704
    s_mov_b64 exec, -1
    v_exp_f32 v26, v26
    v_exp_f32 v27, v27
    v_exp_f32 v28, v28
    v_exp_f32 v29, v29
    v_mfma_f32_32x32x16_bf16 v[64:79], v[180:183], v[140:143], v[64:79]
    buffer_load_dwordx4 v[140:143], v95, s[44:47], s84 offen sc1
    buffer_load_dwordx4 v[176:179], v95, s[48:51], s85 offen sc1
    buffer_load_dwordx4 v[180:183], v95, s[48:51], s85 offen offset:1024 sc1
    s_add_u32 s84, s84, 1024
    s_add_u32 s85, s85, 2048
    v_exp_f32 v30, v30
    v_exp_f32 v31, v31
    v_add_u32 v93, 8192, v93
    v_add_u32 v94, 8192, v94
    s_add_u32 s83, s83, 1
L_LOOPB:
    s_setprio 3
    s_waitcnt lgkmcnt(3)
    v_exp_f32 v0, v0
    v_exp_f32 v1, v1
    v_smfmac_f32_32x32x32_bf16 v[144:159], v[172:175], v[24:31], v92
    v_exp_f32 v2, v2
    v_exp_f32 v3, v3
    v_exp_f32 v4, v4
    v_exp_f32 v5, v5
    v_mfma_f32_32x32x16_bf16 v[16:31], v[88:91], v[80:83], v[32:47]
    ds_read_b128 v[88:91], v93 offset:3072
    v_exp_f32 v6, v6
    v_exp_f32 v7, v7
    v_exp_f32 v8, v8
    v_exp_f32 v9, v9
    v_smfmac_f32_32x32x32_bf16 v[144:159], v[160:163], v[0:7], v92
    s_mov_b64 exec, s[80:81]
    ds_read_b128 v[160:163], v94 offset:2048
    ds_read_b128 v[172:175], v94 offset:1536
    s_mov_b64 exec, -1
    v_exp_f32 v10, v10
    v_exp_f32 v11, v11
    v_exp_f32 v12, v12
    v_exp_f32 v13, v13
    s_waitcnt vmcnt(9)
    v_mfma_f32_32x32x16_bf16 v[48:63], v[108:111], v[104:107], v[48:63]
    v_exp_f32 v14, v14
    v_exp_f32 v15, v15
    s_waitcnt lgkmcnt(3)
    v_exp_f32 v16, v16
    v_exp_f32 v17, v17
    v_smfmac_f32_32x32x32_bf16 v[144:159], v[168:171], v[8:15], v92
    v_exp_f32 v18, v18
    v_exp_f32 v19, v19
    v_exp_f32 v20, v20
    v_exp_f32 v21, v21
    v_mfma_f32_32x32x16_bf16 v[0:15], v[84:87], v[80:83], v[32:47]
    ds_read_b128 v[84:87], v93 offset:4096
    v_exp_f32 v22, v22
    v_exp_f32 v23, v23
    v_exp_f32 v24, v24
    v_exp_f32 v25, v25
    v_smfmac_f32_32x32x32_bf16 v[144:159], v[164:167], v[16:23], v92
    s_mov_b64 exec, s[80:81]
    ds_read_b128 v[164:167], v94 offset:3072
    ds_read_b128 v[168:171], v94 offset:2560
    s_mov_b64 exec, -1
    v_exp_f32 v26, v26
    v_exp_f32 v27, v27
    v_exp_f32 v28, v28
    v_exp_f32 v29, v29
    v_mfma_f32_32x32x16_bf16 v[64:79], v[112:115], v[104:107], v[64:79]
    buffer_load_dwordx4 v[104:107], v95, s[44:47], s84 offen sc1
    buffer_load_dwordx4 v[108:111], v95, s[48:51], s85 offen sc1
    buffer_load_dwordx4 v[112:115], v95, s[48:51], s85 offen offset:1024 sc1
    s_add_u32 s84, s84, 1024
    s_add_u32 s85, s85, 2048
    v_exp_f32 v30, v30
    v_exp_f32 v31, v31
    s_setprio 2
    s_waitcnt lgkmcnt(3)
    v_exp_f32 v0, v0
    v_exp_f32 v1, v1
    v_smfmac_f32_32x32x32_bf16 v[144:159], v[172:175], v[24:31], v92
    v_exp_f32 v2, v2
    v_exp_f32 v3, v3
    v_exp_f32 v4, v4
    v_exp_f32 v5, v5
    v_mfma_f32_32x32x16_bf16 v[16:31], v[88:91], v[80:83], v[32:47]
    ds_read_b128 v[88:91], v93 offset:5120
    v_exp_f32 v6, v6
    v_exp_f32 v7, v7
    v_exp_f32 v8, v8
    v_exp_f32 v9, v9
    v_smfmac_f32_32x32x32_bf16 v[144:159], v[160:163], v[0:7], v92
    s_mov_b64 exec, s[80:81]
    ds_read_b128 v[160:163], v94 offset:4096
    ds_read_b128 v[172:175], v94 offset:3584
    s_mov_b64 exec, -1
    v_exp_f32 v10, v10
    v_exp_f32 v11, v11
    v_exp_f32 v12, v12
    v_exp_f32 v13, v13
    s_waitcnt vmcnt(9)
    v_mfma_f32_32x32x16_bf16 v[48:63], v[120:123], v[116:119], v[48:63]
    v_exp_f32 v14, v14
    v_exp_f32 v15, v15
    s_waitcnt lgkmcnt(3)
    v_exp_f32 v16, v16
    v_exp_f32 v17, v17
    v_smfmac_f32_32x32x32_bf16 v[144:159], v[168:171], v[8:15], v92
    v_exp_f32 v18, v18
    v_exp_f32 v19, v19
    v_exp_f32 v20, v20
    v_exp_f32 v21, v21
    v_mfma_f32_32x32x16_bf16 v[0:15], v[84:87], v[80:83], v[32:47]
    ds_read_b128 v[84:87], v93 offset:6144
    v_exp_f32 v22, v22
    v_exp_f32 v23, v23
    v_exp_f32 v24, v24
    v_exp_f32 v25, v25
    v_smfmac_f32_32x32x32_bf16 v[144:159], v[164:167], v[16:23], v92
    s_mov_b64 exec, s[80:81]
    ds_read_b128 v[164:167], v94 offset:5120
    ds_read_b128 v[168:171], v94 offset:4608
    s_mov_b64 exec, -1
    v_exp_f32 v26, v26
    v_exp_f32 v27, v27
    v_exp_f32 v28, v28
    v_exp_f32 v29, v29
    v_mfma_f32_32x32x16_bf16 v[64:79], v[124:127], v[116:119], v[64:79]
    buffer_load_dwordx4 v[116:119], v95, s[44:47], s84 offen sc1
    buffer_load_dwordx4 v[120:123], v95, s[48:51], s85 offen sc1
    buffer_load_dwordx4 v[124:127], v95, s[48:51], s85 offen offset:1024 sc1
    s_add_u32 s84, s84, 1024
    s_add_u32 s85, s85, 2048
    v_exp_f32 v30, v30
    v_exp_f32 v31, v31
    s_setprio 1
    s_waitcnt lgkmcnt(3)
    v_exp_f32 v0, v0
    v_exp_f32 v1, v1
    v_smfmac_f32_32x32x32_bf16 v[144:159], v[172:175], v[24:31], v92
    v_exp_f32 v2, v2
    v_exp_f32 v3, v3
    v_exp_f32 v4, v4
    v_exp_f32 v5, v5
    v_mfma_f32_32x32x16_bf16 v[16:31], v[88:91], v[80:83], v[32:47]
    ds_read_b128 v[88:91], v93 offset:7168
    v_exp_f32 v6, v6
    v_exp_f32 v7, v7
    v_exp_f32 v8, v8
    v_exp_f32 v9, v9
    v_smfmac_f32_32x32x32_bf16 v[144:159], v[160:163], v[0:7], v92
    s_mov_b64 exec, s[80:81]
    ds_read_b128 v[160:163], v94 offset:6144
    ds_read_b128 v[172:175], v94 offset:5632
    s_mov_b64 exec, -1
    v_exp_f32 v10, v10
    v_exp_f32 v11, v11
    v_exp_f32 v12, v12
    v_exp_f32 v13, v13
    s_waitcnt vmcnt(9)
    v_mfma_f32_32x32x16_bf16 v[48:63], v[132:135], v[128:131], v[48:63]
    v_exp_f32 v14, v14
    v_exp_f32 v15, v15
    s_waitcnt lgkmcnt(3)
    v_exp_f32 v16, v16
    v_exp_f32 v17, v17
    v_smfmac_f32_32x32x32_bf16 v[144:159], v[168:171], v[8:15], v92
    v_exp_f32 v18, v18
    v_exp_f32 v19, v19
    v_exp_f32 v20, v20
    v_exp_f32 v21, v21
    v_mfma_f32_32x32x16_bf16 v[0:15], v[84:87], v[80:83], v[32:47]
    ds_read_b128 v[84:87], v93 offset:8192
    v_exp_f32 v22, v22
    v_exp_f32 v23, v23
    v_exp_f32 v24, v24
    v_exp_f32 v25, v25
    v_smfmac_f32_32x32x32_bf16 v[144:159], v[164:167], v[16:23], v92
    s_mov_b64 exec, s[80:81]
    ds_read_b128 v[164:167], v94 offset:7168
    ds_read_b128 v[168:171], v94 offset:6656
    s_mov_b64 exec, -1
    v_exp_f32 v26, v26
    v_exp_f32 v27, v27
    v_exp_f32 v28, v28
    v_exp_f32 v29, v29
    v_mfma_f32_32x32x16_bf16 v[64:79], v[136:139], v[128:131], v[64:79]
    buffer_load_dwordx4 v[128:131], v95, s[44:47], s84 offen sc1
    buffer_load_dwordx4 v[132:135], v95, s[48:51], s85 offen sc1
    buffer_load_dwordx4 v[136:139], v95, s[48:51], s85 offen offset:1024 sc1
    s_add_u32 s84, s84, 1024
    s_add_u32 s85, s85, 2048
    v_exp_f32 v30, v30
    v_exp_f32 v31, v31
    s_setprio 0
    s_waitcnt lgkmcnt(3)
    v_exp_f32 v0, v0
    v_exp_f32 v1, v1
    v_smfmac_f32_32x32x32_bf16 v[144:159], v[172:175], v[24:31], v92
    v_exp_f32 v2, v2
    v_exp_f32 v3, v3
    v_exp_f32 v4, v4
    v_exp_f32 v5, v5
    v_mfma_f32_32x32x16_bf16 v[16:31], v[88:91], v[80:83], v[32:47]
    ds_read_b128 v[88:91], v93 offset:9216
    v_exp_f32 v6, v6
    v_exp_f32 v7, v7
    v_exp_f32 v8, v8
    v_exp_f32 v9, v9
    v_smfmac_f32_32x32x32_bf16 v[144:159], v[160:163], v[0:7], v92
    s_mov_b64 exec, s[80:81]
    ds_read_b128 v[160:163], v94 offset:8192
    ds_read_b128 v[172:175], v94 offset:7680
    s_mov_b64 exec, -1
    v_exp_f32 v10, v10
    v_exp_f32 v11, v11
    v_exp_f32 v12, v12
    v_exp_f32 v13, v13
    s_waitcnt vmcnt(9)
    v_mfma_f32_32x32x16_bf16 v[48:63], v[176:179], v[140:143], v[48:63]
    v_exp_f32 v14, v14
    v_exp_f32 v15, v15
    s_waitcnt lgkmcnt(3)
    v_exp_f32 v16, v16
    v_exp_f32 v17, v17
    v_smfmac_f32_32x32x32_bf16 v[144:159], v[168:171], v[8:15], v92
    v_exp_f32 v18, v18
    v_exp_f32 v19, v19
    v_exp_f32 v20, v20
    v_exp_f32 v21, v21
    v_mfma_f32_32x32x16_bf16 v[0:15], v[84:87], v[80:83], v[32:47]
    ds_read_b128 v[84:87], v93 offset:10240
    v_exp_f32 v22, v22
    v_exp_f32 v23, v23
    v_exp_f32 v24, v24
    v_exp_f32 v25, v25
    v_smfmac_f32_32x32x32_bf16 v[144:159], v[164:167], v[16:23], v92
    s_mov_b64 exec, s[80:81]
    ds_read_b128 v[164:167], v94 offset:9216
    ds_read_b128 v[168:171], v94 offset:8704
    s_mov_b64 exec, -1
    v_exp_f32 v26, v26
    v_exp_f32 v27, v27
    v_exp_f32 v28, v28
    v_exp_f32 v29, v29
    v_mfma_f32_32x32x16_bf16 v[64:79], v[180:183], v[140:143], v[64:79]
    buffer_load_dwordx4 v[140:143], v95, s[44:47], s84 offen sc1
    buffer_load_dwordx4 v[176:179], v95, s[48:51], s85 offen sc1
    buffer_load_dwordx4 v[180:183], v95, s[48:51], s85 offen offset:1024 sc1
    s_add_u32 s84, s84, 1024
    s_add_u32 s85, s85, 2048
    v_exp_f32 v30, v30
    v_exp_f32 v31, v31
    v_add_u32 v93, 8192, v93
    v_add_u32 v94, 8192, v94
    s_add_u32 s83, s83, 1
    s_cmp_lt_u32 s83, 7
    s_cbranch_scc1 L_LOOPB
    s_setprio 3
    s_waitcnt lgkmcnt(3)
    v_exp_f32 v0, v0
    v_exp_f32 v1, v1
    v_smfmac_f32_32x32x32_bf16 v[144:159], v[172:175], v[24:31], v92
    v_exp_f32 v2, v2
    v_exp_f32 v3, v3
    v_exp_f32 v4, v4
    v_exp_f32 v5, v5
    v_mfma_f32_32x32x16_bf16 v[16:31], v[88:91], v[80:83], v[32:47]
    ds_read_b128 v[88:91], v93 offset:3072
    v_exp_f32 v6, v6
    v_exp_f32 v7, v7
    v_exp_f32 v8, v8
    v_exp_f32 v9, v9
    v_smfmac_f32_32x32x32_bf16 v[144:159], v[160:163], v[0:7], v92
    s_mov_b64 exec, s[80:81]
    ds_read_b128 v[160:163], v94 offset:2048
    ds_read_b128 v[172:175], v94 offset:1536
    s_mov_b64 exec, -1
    buffer_load_dwordx4 v[248:251], v252, s[24:27], s88 offen
    buffer_load_dwordx4 v[184:187], v95, s[32:35], s90 offen offset:0 sc1
    buffer_load_dwordx4 v[188:191], v95, s[32:35], s90 offen offset:1024 sc1
    v_exp_f32 v10, v10
    v_exp_f32 v11, v11
    s_waitcnt vmcnt(12)
    v_mfma_f32_32x32x16_bf16 v[48:63], v[108:111], v[104:107], v[48:63]
    v_exp_f32 v12, v12
    v_exp_f32 v13, v13
    v_exp_f32 v14, v14
    v_exp_f32 v15, v15
    v_mfma_f32_32x32x16_bf16 v[64:79], v[112:115], v[104:107], v[64:79]
    s_waitcnt lgkmcnt(3)
    v_exp_f32 v16, v16
    v_exp_f32 v17, v17
    v_smfmac_f32_32x32x32_bf16 v[144:159], v[168:171], v[8:15], v92
    v_exp_f32 v18, v18
    v_exp_f32 v19, v19
    v_exp_f32 v20, v20
    v_exp_f32 v21, v21
    v_mfma_f32_32x32x16_bf16 v[0:15], v[84:87], v[80:83], v[32:47]
    ds_read_b128 v[84:87], v93 offset:4096
    v_exp_f32 v22, v22
    v_exp_f32 v23, v23
    v_exp_f32 v24, v24
    v_exp_f32 v25, v25
    v_smfmac_f32_32x32x32_bf16 v[144:159], v[164:167], v[16:23], v92
    s_mov_b64 exec, s[80:81]
    ds_read_b128 v[164:167], v94 offset:3072
    ds_read_b128 v[168:171], v94 offset:2560
    s_mov_b64 exec, -1
    buffer_load_dwordx4 v[192:195], v95, s[32:35], s90 offen offset:2048 sc1
    buffer_load_dwordx4 v[196:199], v95, s[32:35], s90 offen offset:3072 sc1
    s_add_u32 s90, s90, 4096
    v_exp_f32 v26, v26
    v_exp_f32 v27, v27
    s_waitcnt vmcnt(11)
    v_mfma_f32_32x32x16_bf16 v[48:63], v[120:123], v[116:119], v[48:63]
    v_exp_f32 v28, v28
    v_exp_f32 v29, v29
    v_exp_f32 v30, v30
    v_exp_f32 v31, v31
    v_mfma_f32_32x32x16_bf16 v[64:79], v[124:127], v[116:119], v[64:79]
    s_barrier
    s_setprio 2
    s_waitcnt lgkmcnt(3)
    v_exp_f32 v0, v0
    v_exp_f32 v1, v1
    v_smfmac_f32_32x32x32_bf16 v[144:159], v[172:175], v[24:31], v92
    v_exp_f32 v2, v2
    v_exp_f32 v3, v3
    v_exp_f32 v4, v4
    v_exp_f32 v5, v5
    v_mfma_f32_32x32x16_bf16 v[16:31], v[88:91], v[80:83], v[32:47]
    ds_read_b128 v[88:91], v93 offset:5120
    v_exp_f32 v6, v6
    v_exp_f32 v7, v7
    v_exp_f32 v8, v8
    v_exp_f32 v9, v9
    v_smfmac_f32_32x32x32_bf16 v[144:159], v[160:163], v[0:7], v92
    s_mov_b64 exec, s[80:81]
    ds_read_b128 v[160:163], v94 offset:4096
    ds_read_b128 v[172:175], v94 offset:3584
    s_mov_b64 exec, -1
    buffer_load_dwordx4 v[200:203], v95, s[32:35], s90 offen offset:0 sc1
    buffer_load_dwordx4 v[204:207], v95, s[32:35], s90 offen offset:1024 sc1
    v_exp_f32 v10, v10
    v_exp_f32 v11, v11
    s_waitcnt vmcnt(10)
    v_mfma_f32_32x32x16_bf16 v[48:63], v[132:135], v[128:131], v[48:63]
    v_exp_f32 v12, v12
    v_exp_f32 v13, v13
    v_exp_f32 v14, v14
    v_exp_f32 v15, v15
    v_mfma_f32_32x32x16_bf16 v[64:79], v[136:139], v[128:131], v[64:79]
    s_waitcnt lgkmcnt(3)
    v_exp_f32 v16, v16
    v_exp_f32 v17, v17
    v_smfmac_f32_32x32x32_bf16 v[144:159], v[168:171], v[8:15], v92
    v_exp_f32 v18, v18
    v_exp_f32 v19, v19
    v_exp_f32 v20, v20
    v_exp_f32 v21, v21
    v_mfma_f32_32x32x16_bf16 v[0:15], v[84:87], v[80:83], v[32:47]
    ds_read_b128 v[84:87], v93 offset:6144
    v_exp_f32 v22, v22
    v_exp_f32 v23, v23
    v_exp_f32 v24, v24
    v_exp_f32 v25, v25
    v_smfmac_f32_32x32x32_bf16 v[144:159], v[164:167], v[16:23], v92
    s_mov_b64 exec, s[80:81]
    ds_read_b128 v[164:167], v94 offset:5120
    ds_read_b128 v[168:171], v94 offset:4608
    s_mov_b64 exec, -1
    buffer_load_dwordx4 v[208:211], v95, s[32:35], s90 offen offset:2048 sc1
    buffer_load_dwordx4 v[212:215], v95, s[32:35], s90 offen offset:3072 sc1
    s_add_u32 s90, s90, 4096
    v_exp_f32 v26, v26
    v_exp_f32 v27, v27
    s_waitcnt vmcnt(9)
    v_mfma_f32_32x32x16_bf16 v[48:63], v[176:179], v[140:143], v[48:63]
    v_exp_f32 v28, v28
    v_exp_f32 v29, v29
    v_exp_f32 v30, v30
    v_exp_f32 v31, v31
    v_mfma_f32_32x32x16_bf16 v[64:79], v[180:183], v[140:143], v[64:79]
    s_setprio 1
    s_waitcnt lgkmcnt(3)
    v_exp_f32 v0, v0
    v_exp_f32 v1, v1
    v_smfmac_f32_32x32x32_bf16 v[144:159], v[172:175], v[24:31], v92
    v_exp_f32 v2, v2
    v_exp_f32 v3, v3
    v_exp_f32 v4, v4
    v_exp_f32 v5, v5
    v_exp_f32 v6, v6
    v_mfma_f32_32x32x16_bf16 v[16:31], v[88:91], v[80:83], v[32:47]
    ds_read_b128 v[88:91], v93 offset:7168
    v_exp_f32 v7, v7
    v_exp_f32 v8, v8
    v_exp_f32 v9, v9
    v_exp_f32 v10, v10
    v_exp_f32 v11, v11
    v_smfmac_f32_32x32x32_bf16 v[144:159], v[160:163], v[0:7], v92
    s_mov_b64 exec, s[80:81]
    ds_read_b128 v[160:163], v94 offset:6144
    ds_read_b128 v[172:175], v94 offset:5632
    s_mov_b64 exec, -1
    buffer_load_dwordx4 v[216:219], v95, s[32:35], s90 offen offset:0 sc1
    buffer_load_dwordx4 v[220:223], v95, s[32:35], s90 offen offset:1024 sc1
    ds_write_b128 v102, v[48:51] offset:0
    ds_write_b128 v102, v[52:55] offset:1056
    v_exp_f32 v12, v12
    v_exp_f32 v13, v13
    v_exp_f32 v14, v14
    v_exp_f32 v15, v15
    s_waitcnt lgkmcnt(5)
    v_exp_f32 v16, v16
    v_exp_f32 v17, v17
    v_smfmac_f32_32x32x32_bf16 v[144:159], v[168:171], v[8:15], v92
    v_exp_f32 v18, v18
    v_exp_f32 v19, v19
    v_exp_f32 v20, v20
    v_exp_f32 v21, v21
    v_exp_f32 v22, v22
    v_mfma_f32_32x32x16_bf16 v[0:15], v[84:87], v[80:83], v[32:47]
    ds_read_b128 v[84:87], v93 offset:8192
    v_exp_f32 v23, v23
    v_exp_f32 v24, v24
    v_exp_f32 v25, v25
    v_exp_f32 v26, v26
    v_exp_f32 v27, v27
    v_smfmac_f32_32x32x32_bf16 v[144:159], v[164:167], v[16:23], v92
    s_mov_b64 exec, s[80:81]
    ds_read_b128 v[164:167], v94 offset:7168
    ds_read_b128 v[168:171], v94 offset:6656
    s_mov_b64 exec, -1
    buffer_load_dwordx4 v[224:227], v95, s[32:35], s90 offen offset:2048 sc1
    buffer_load_dwordx4 v[228:231], v95, s[32:35], s90 offen offset:3072 sc1
    s_add_u32 s90, s90, 4096
    ds_write_b128 v102, v[56:59] offset:2112
    ds_write_b128 v102, v[60:63] offset:3168
    v_exp_f32 v28, v28
    v_exp_f32 v29, v29
    v_exp_f32 v30, v30
    v_exp_f32 v31, v31
    s_setprio 0
    s_waitcnt lgkmcnt(5)
    v_exp_f32 v0, v0
    v_exp_f32 v1, v1
    v_smfmac_f32_32x32x32_bf16 v[144:159], v[172:175], v[24:31], v92
    v_exp_f32 v2, v2
    v_exp_f32 v3, v3
    v_exp_f32 v4, v4
    v_exp_f32 v5, v5
    v_exp_f32 v6, v6
    v_mfma_f32_32x32x16_bf16 v[16:31], v[88:91], v[80:83], v[32:47]
    ds_read_b128 v[88:91], v93 offset:9216
    v_exp_f32 v7, v7
    v_exp_f32 v8, v8
    v_exp_f32 v9, v9
    v_exp_f32 v10, v10
    v_exp_f32 v11, v11
    v_smfmac_f32_32x32x32_bf16 v[144:159], v[160:163], v[0:7], v92
    s_mov_b64 exec, s[80:81]
    ds_read_b128 v[160:163], v94 offset:8192
    ds_read_b128 v[172:175], v94 offset:7680
    s_mov_b64 exec, -1
    buffer_load_dwordx4 v[232:235], v95, s[32:35], s90 offen offset:0 sc1
    buffer_load_dwordx4 v[236:239], v95, s[32:35], s90 offen offset:1024 sc1
    ds_write_b128 v102, v[64:67] offset:4224
    ds_write_b128 v102, v[68:71] offset:5280
    v_exp_f32 v12, v12
    v_exp_f32 v13, v13
    v_exp_f32 v14, v14
    v_exp_f32 v15, v15
    s_waitcnt lgkmcnt(5)
    v_exp_f32 v16, v16
    v_exp_f32 v17, v17
    v_smfmac_f32_32x32x32_bf16 v[144:159], v[168:171], v[8:15], v92
    v_exp_f32 v18, v18
    v_exp_f32 v19, v19
    v_exp_f32 v20, v20
    v_exp_f32 v21, v21
    v_exp_f32 v22, v22
    v_mfma_f32_32x32x16_bf16 v[0:15], v[84:87], v[80:83], v[32:47]
    ds_read_b128 v[84:87], v93 offset:10240
    v_exp_f32 v23, v23
    v_exp_f32 v24, v24
    v_exp_f32 v25, v25
    v_exp_f32 v26, v26
    v_exp_f32 v27, v27
    v_smfmac_f32_32x32x32_bf16 v[144:159], v[164:167], v[16:23], v92
    s_mov_b64 exec, s[80:81]
    ds_read_b128 v[164:167], v94 offset:9216
    ds_read_b128 v[168:171], v94 offset:8704
    s_mov_b64 exec, -1
    buffer_load_dwordx4 v[240:243], v95, s[32:35], s90 offen offset:2048 sc1
    buffer_load_dwordx4 v[244:247], v95, s[32:35], s90 offen offset:3072 sc1
    s_add_u32 s90, s90, 4096
    ds_write_b128 v102, v[72:75] offset:6336
    ds_write_b128 v102, v[76:79] offset:7392
    v_exp_f32 v28, v28
    v_exp_f32 v29, v29
    v_exp_f32 v30, v30
    v_exp_f32 v31, v31
L_ATT_DONE:
    s_setprio 3
    s_waitcnt lgkmcnt(0)
    v_smfmac_f32_32x32x32_bf16 v[144:159], v[172:175], v[24:31], v92
    s_nop 0
    v_mov_b32 v96, 0x6c800000
    v_mov_b32 v97, 0x7b800000
    v_mov_b32 v99, 0xd800000
    s_nop 7
    v_rcp_f32 v101, v152
    s_nop 0
    v_mul_f32 v101, 0x2f800000, v101
    v_mul_f32 v0, v144, v101
    v_mul_f32 v1, v145, v101
    v_mul_f32 v2, v146, v101
    v_mul_f32 v3, v147, v101
    v_mul_f32 v4, v148, v101
    v_mul_f32 v5, v149, v101
    v_mul_f32 v6, v150, v101
    v_mul_f32 v7, v151, v101
    v_cvt_pk_bf16_f32 v8, v0, v1
    v_cvt_pk_bf16_f32 v9, v2, v3
    v_cvt_pk_bf16_f32 v10, v4, v5
    v_cvt_pk_bf16_f32 v11, v6, v7
    s_cmp_eq_u32 s82, 0
    s_cbranch_scc1 L_FIN
    v_add_f32 v100, abs(v144), abs(v145)
    v_add_f32 v100, v100, abs(v146)
    v_add_f32 v100, v100, abs(v147)
    v_add_f32 v100, v100, abs(v148)
    v_add_f32 v100, v100, abs(v149)
    v_add_f32 v100, v100, abs(v150)
    v_add_f32 v100, v100, abs(v151)
    v_cmp_nlt_f32 s[62:63], v152, v96
    v_cmp_nlt_f32 s[64:65], v100, v97
    v_cmp_lt_f32 vcc, v100, v99
    s_or_b64 s[62:63], s[62:63], s[64:65]
    s_or_b64 s[62:63], s[62:63], vcc
    s_cmp_eq_u64 s[62:63], 0
    s_cbranch_scc0 L_EXACT
L_FIN:
    buffer_store_dwordx4 v[8:11], v95, s[32:35], s11 offen sc1
    s_barrier
    ds_read_b128 v[48:51], v103 offset:0
    ds_read_b128 v[52:55], v103 offset:512
    ds_read_b128 v[56:59], v103 offset:8448
    ds_read_b128 v[60:63], v103 offset:8960
    ds_read_b128 v[64:67], v103 offset:16896
    ds_read_b128 v[68:71], v103 offset:17408
    ds_read_b128 v[72:75], v103 offset:25344
    ds_read_b128 v[76:79], v103 offset:25856
    s_waitcnt vmcnt(1)
    v_add_u32 v102, 33792, v102
    v_add_u32 v103, 33792, v103
    v_lshlrev_b32 v144, 16, v248
    v_and_b32 v145, 0xffff0000, v248
    v_lshlrev_b32 v146, 16, v249
    v_and_b32 v147, 0xffff0000, v249
    v_lshlrev_b32 v148, 16, v250
    v_and_b32 v149, 0xffff0000, v250
    v_lshlrev_b32 v150, 16, v251
    v_and_b32 v151, 0xffff0000, v251
    s_waitcnt lgkmcnt(0)
    v_add_f32 v48, v48, v56
    v_add_f32 v64, v64, v72
    v_add_f32 v49, v49, v57
    v_add_f32 v65, v65, v73
    v_add_f32 v50, v50, v58
    v_add_f32 v66, v66, v74
    v_add_f32 v51, v51, v59
    v_add_f32 v67, v67, v75
    v_add_f32 v52, v52, v60
    v_add_f32 v68, v68, v76
    v_add_f32 v53, v53, v61
    v_add_f32 v69, v69, v77
    v_add_f32 v54, v54, v62
    v_add_f32 v70, v70, v78
    v_add_f32 v55, v55, v63
    v_add_f32 v71, v71, v79
    v_add_f32 v48, v48, v64
    v_add_f32 v49, v49, v65
    v_add_f32 v50, v50, v66
    v_add_f32 v51, v51, v67
    v_add_f32 v52, v52, v68
    v_add_f32 v53, v53, v69
    v_add_f32 v54, v54, v70
    v_add_f32 v55, v55, v71
    v_mul_f32 v136, 0xbfb8aa3b, v48
    v_mul_f32 v137, 0xbfb8aa3b, v49
    v_mul_f32 v138, 0xbfb8aa3b, v50
    v_mul_f32 v139, 0xbfb8aa3b, v51
    v_mul_f32 v140, 0xbfb8aa3b, v52
    v_mul_f32 v141, 0xbfb8aa3b, v53
    v_mul_f32 v142, 0xbfb8aa3b, v54
    v_mul_f32 v143, 0xbfb8aa3b, v55
    v_exp_f32 v136, v136
    v_exp_f32 v137, v137
    v_exp_f32 v138, v138
    v_exp_f32 v139, v139
    v_exp_f32 v140, v140
    v_exp_f32 v141, v141
    v_exp_f32 v142, v142
    v_exp_f32 v143, v143
    v_add_f32 v136, 1.0, v136
    v_add_f32 v137, 1.0, v137
    v_add_f32 v138, 1.0, v138
    v_add_f32 v139, 1.0, v139
    v_add_f32 v140, 1.0, v140
    v_add_f32 v141, 1.0, v141
    v_add_f32 v142, 1.0, v142
    v_add_f32 v143, 1.0, v143
    v_rcp_f32 v136, v136
    v_rcp_f32 v137, v137
    v_rcp_f32 v138, v138
    v_rcp_f32 v139, v139
    v_rcp_f32 v140, v140
    v_rcp_f32 v141, v141
    v_rcp_f32 v142, v142
    v_rcp_f32 v143, v143
    v_mul_f32 v48, v48, v136
    v_mul_f32 v49, v49, v137
    v_mul_f32 v50, v50, v138
    v_mul_f32 v51, v51, v139
    v_mul_f32 v52, v52, v140
    v_mul_f32 v53, v53, v141
    v_mul_f32 v54, v54, v142
    v_mul_f32 v55, v55, v143
    buffer_load_dwordx4 v[16:19], v95, s[32:35], s87 offen offset:0 sc1
    buffer_load_dwordx4 v[20:23], v95, s[32:35], s87 offen offset:1024 sc1
    buffer_load_dwordx4 v[24:27], v95, s[32:35], s87 offen offset:2048 sc1
    buffer_load_dwordx4 v[28:31], v95, s[32:35], s87 offen offset:3072 sc1
    buffer_load_dwordx4 v[32:35], v95, s[32:35], s13 offen offset:0 sc1
    buffer_load_dwordx4 v[36:39], v95, s[32:35], s13 offen offset:1024 sc1
    buffer_load_dwordx4 v[40:43], v95, s[32:35], s13 offen offset:2048 sc1
    buffer_load_dwordx4 v[44:47], v95, s[32:35], s13 offen offset:3072 sc1
    s_mov_b32 s70, 20000
L_OW0:
    s_waitcnt vmcnt(7)
    v_max3_u32 v96, v16, v17, v18
    v_max_u32 v96, v96, v19
    v_cmp_eq_u32 vcc, -1, v96
    s_cmp_lg_u64 vcc, 0
    s_cbranch_scc1 L_OR0
L_OK0:
    v_mfma_f32_32x32x16_bf16 v[104:119], v[184:187], v[16:19], 0
    v_mfma_f32_32x32x16_bf16 v[120:135], v[188:191], v[16:19], 0
L_OW1:
    s_waitcnt vmcnt(6)
    v_max3_u32 v96, v20, v21, v22
    v_max_u32 v96, v96, v23
    v_cmp_eq_u32 vcc, -1, v96
    s_cmp_lg_u64 vcc, 0
    s_cbranch_scc1 L_OR1
L_OK1:
    v_mfma_f32_32x32x16_bf16 v[104:119], v[192:195], v[20:23], v[104:119]
    v_mfma_f32_32x32x16_bf16 v[120:135], v[196:199], v[20:23], v[120:135]
L_OW2:
    s_waitcnt vmcnt(5)
    v_max3_u32 v96, v24, v25, v26
    v_max_u32 v96, v96, v27
    v_cmp_eq_u32 vcc, -1, v96
    s_cmp_lg_u64 vcc, 0
    s_cbranch_scc1 L_OR2
L_OK2:
    v_mfma_f32_32x32x16_bf16 v[104:119], v[200:203], v[24:27], v[104:119]
    v_mfma_f32_32x32x16_bf16 v[120:135], v[204:207], v[24:27], v[120:135]
L_OW3:
    s_waitcnt vmcnt(4)
    v_max3_u32 v96, v28, v29, v30
    v_max_u32 v96, v96, v31
    v_cmp_eq_u32 vcc, -1, v96
    s_cmp_lg_u64 vcc, 0
    s_cbranch_scc1 L_OR3
L_OK3:
    v_mfma_f32_32x32x16_bf16 v[104:119], v[208:211], v[28:31], v[104:119]
    v_mfma_f32_32x32x16_bf16 v[120:135], v[212:215], v[28:31], v[120:135]
L_OW4:
    s_waitcnt vmcnt(3)
    v_max3_u32 v96, v32, v33, v34
    v_max_u32 v96, v96, v35
    v_cmp_eq_u32 vcc, -1, v96
    s_cmp_lg_u64 vcc, 0
    s_cbranch_scc1 L_OR4
L_OK4:
    v_mfma_f32_32x32x16_bf16 v[104:119], v[216:219], v[32:35], v[104:119]
    v_mfma_f32_32x32x16_bf16 v[120:135], v[220:223], v[32:35], v[120:135]
L_OW5:
    s_waitcnt vmcnt(2)
    v_max3_u32 v96, v36, v37, v38
    v_max_u32 v96, v96, v39
    v_cmp_eq_u32 vcc, -1, v96
    s_cmp_lg_u64 vcc, 0
    s_cbranch_scc1 L_OR5
L_OK5:
    v_mfma_f32_32x32x16_bf16 v[104:119], v[224:227], v[36:39], v[104:119]
    v_mfma_f32_32x32x16_bf16 v[120:135], v[228:231], v[36:39], v[120:135]
L_OW6:
    s_waitcnt vmcnt(1)
    v_max3_u32 v96, v40, v41, v42
    v_max_u32 v96, v96, v43
    v_cmp_eq_u32 vcc, -1, v96
    s_cmp_lg_u64 vcc, 0
    s_cbranch_scc1 L_OR6
L_OK6:
    v_mfma_f32_32x32x16_bf16 v[104:119], v[232:235], v[40:43], v[104:119]
    v_mfma_f32_32x32x16_bf16 v[120:135], v[236:239], v[40:43], v[120:135]
L_OW7:
    s_waitcnt vmcnt(0)
    v_max3_u32 v96, v44, v45, v46
    v_max_u32 v96, v96, v47
    v_cmp_eq_u32 vcc, -1, v96
    s_cmp_lg_u64 vcc, 0
    s_cbranch_scc1 L_OR7
L_OK7:
    v_mfma_f32_32x32x16_bf16 v[104:119], v[240:243], v[44:47], v[104:119]
    v_mfma_f32_32x32x16_bf16 v[120:135], v[244:247], v[44:47], v[120:135]
    s_nop 11
    ds_write_b128 v102, v[104:107] offset:0
    ds_write_b128 v102, v[108:111] offset:1056
    ds_write_b128 v102, v[112:115] offset:2112
    ds_write_b128 v102, v[116:119] offset:3168
    ds_write_b128 v102, v[120:123] offset:4224
    ds_write_b128 v102, v[124:127] offset:5280
    ds_write_b128 v102, v[128:131] offset:6336
    ds_write_b128 v102, v[132:135] offset:7392
    s_waitcnt lgkmcnt(0)
    s_barrier
    ds_read_b128 v[0:3], v103 offset:0
    ds_read_b128 v[4:7], v103 offset:512
    ds_read_b128 v[8:11], v103 offset:8448
    ds_read_b128 v[12:15], v103 offset:8960
    ds_read_b128 v[16:19], v103 offset:16896
    ds_read_b128 v[20:23], v103 offset:17408
    ds_read_b128 v[24:27], v103 offset:25344
    ds_read_b128 v[28:31], v103 offset:25856
    s_waitcnt lgkmcnt(0)
    v_add_f32 v0, v0, v8
    v_add_f32 v16, v16, v24
    v_add_f32 v1, v1, v9
    v_add_f32 v17, v17, v25
    v_add_f32 v2, v2, v10
    v_add_f32 v18, v18, v26
    v_add_f32 v3, v3, v11
    v_add_f32 v19, v19, v27
    v_add_f32 v4, v4, v12
    v_add_f32 v20, v20, v28
    v_add_f32 v5, v5, v13
    v_add_f32 v21, v21, v29
    v_add_f32 v6, v6, v14
    v_add_f32 v22, v22, v30
    v_add_f32 v7, v7, v15
    v_add_f32 v23, v23, v31
    v_add_f32 v0, v0, v16
    v_add_f32 v1, v1, v17
    v_add_f32 v2, v2, v18
    v_add_f32 v3, v3, v19
    v_add_f32 v4, v4, v20
    v_add_f32 v5, v5, v21
    v_add_f32 v6, v6, v22
    v_add_f32 v7, v7, v23
    v_fma_f32 v0, v0, v48, v144
    v_fma_f32 v1, v1, v49, v145
    v_fma_f32 v2, v2, v50, v146
    v_fma_f32 v3, v3, v51, v147
    v_fma_f32 v4, v4, v52, v148
    v_fma_f32 v5, v5, v53, v149
    v_fma_f32 v6, v6, v54, v150
    v_fma_f32 v7, v7, v55, v151
    v_cvt_pk_bf16_f32 v136, v0, v1
    v_cvt_pk_bf16_f32 v137, v2, v3
    v_cvt_pk_bf16_f32 v138, v4, v5
    v_cvt_pk_bf16_f32 v139, v6, v7
    buffer_store_dwordx4 v[136:139], v252, s[40:43], s88 offen nt
L_END:
    s_endpgm
L_ATTINIT:
    v_mov_b32 v144, 0
    v_mov_b32 v145, 0
    v_mov_b32 v146, 0
    v_mov_b32 v147, 0
    v_mov_b32 v148, 0
    v_mov_b32 v149, 0
    v_mov_b32 v150, 0
    v_mov_b32 v151, 0
    v_mov_b32 v152, 0
    v_mov_b32 v153, 0
    v_mov_b32 v154, 0
    v_mov_b32 v155, 0
    v_mov_b32 v156, 0
    v_mov_b32 v157, 0
    v_mov_b32 v158, 0
    v_mov_b32 v159, 0
    v_mov_b32 v160, 0
    v_mov_b32 v161, 0
    v_mov_b32 v162, 0
    v_mov_b32 v163, 0
    v_mov_b32 v164, 0
    v_mov_b32 v165, 0
    v_mov_b32 v166, 0
    v_mov_b32 v167, 0
    v_mov_b32 v168, 0
    v_mov_b32 v169, 0
    v_mov_b32 v170, 0
    v_mov_b32 v171, 0
    v_mov_b32 v172, 0
    v_mov_b32 v173, 0
    v_mov_b32 v174, 0
    v_mov_b32 v175, 0
    s_mov_b32 s80, 0x00110000
    s_mov_b32 s81, 0x00110000
    s_mov_b64 exec, s[80:81]
    v_mov_b32 v160, 0x3f803f80
    v_mov_b32 v161, 0x3f803f80
    v_mov_b32 v162, 0x3f803f80
    v_mov_b32 v163, 0x3f803f80
    v_mov_b32 v164, 0x3f803f80
    v_mov_b32 v165, 0x3f803f80
    v_mov_b32 v166, 0x3f803f80
    v_mov_b32 v167, 0x3f803f80
    v_mov_b32 v168, 0x3f803f80
    v_mov_b32 v169, 0x3f803f80
    v_mov_b32 v170, 0x3f803f80
    v_mov_b32 v171, 0x3f803f80
    v_mov_b32 v172, 0x3f803f80
    v_mov_b32 v173, 0x3f803f80
    v_mov_b32 v174, 0x3f803f80
    v_mov_b32 v175, 0x3f803f80
    s_mov_b64 exec, -1
    s_mov_b32 s80, 0xffff
    s_mov_b32 s81, 0xffff
    s_mov_b32 s79, 0xc2c40000
    s_mov_b32 s82, 1
    v_and_b32 v251, 7, v254
    v_lshrrev_b32 v252, 3, v254
    v_lshlrev_b32 v252, 10, v252
    v_lshl_add_u32 v252, v251, 4, v252
    s_lshl_b32 s15, s22, 10
    s_add_u32 s15, s15, 135168
    s_and_b32 s91, s20, 3
    s_lshl_b32 s91, s91, 7
    s_add_u32 s91, s91, 0x1100200
    s_and_b32 s75, s2, 7
    s_lshl_b32 s75, s75, 10
    s_add_u32 s75, s75, 0x1100200
    s_lshr_b32 s61, s2, 5
    s_lshl_b32 s61, s61, 3
    s_add_u32 s61, s61, s22
    s_lshl_b32 s61, s61, 5
    s_and_b32 s62, s2, 31
    s_add_u32 s61, s61, s62
    s_lshl_b32 s11, s61, 10
    s_add_u32 s11, s11, 0x600000
    s_and_b32 s94, s2, 31
    s_lshl_b32 s94, s94, 16
    s_lshl_b32 s95, s22, 10
    s_add_u32 s95, s95, 16384
    s_add_u32 s94, s94, s95
    s_add_u32 s94, s94, 0x200000
    s_and_b32 s67, s2, 7
    s_bfe_u32 s61, s2, 0x20003
    s_lshl_b32 s67, s67, 2
    s_add_u32 s67, s67, s61
    s_lshr_b32 s61, s2, 5
    s_and_b32 s62, s22, 1
    s_lshl_b32 s67, s67, 1
    s_add_u32 s67, s67, s62
    s_lshr_b32 s62, s22, 1
    s_mul_i32 s63, s62, 22
    s_cmp_eq_u32 s62, 3
    s_cselect_b32 s63, 65, s63
    s_cmp_lt_u32 s62, 2
    s_cselect_b32 s64, 22, 21
    s_mul_i32 s65, s67, 86
    s_add_u32 s65, s65, s63
    s_lshl_b32 s65, s65, 10
    s_add_u32 s65, s65, 0xb00000
    s_add_u32 s44, s18, s65
    s_addc_u32 s45, s19, 0
    s_lshl_b32 s46, s64, 10
    s_mov_b32 s47, 0x00020000
    s_mul_i32 s65, s61, 86
    s_add_u32 s65, s65, s63
    s_lshl_b32 s65, s65, 11
    s_add_u32 s65, s65, 0x900000
    s_add_u32 s48, s18, s65
    s_addc_u32 s49, s19, 0
    s_lshl_b32 s50, s64, 11
    s_mov_b32 s51, 0x00020000
    s_mov_b32 s84, 0
    s_mov_b32 s85, 0
    s_lshl_b32 s90, s61, 16
    s_lshl_b32 s66, s62, 14
    s_add_u32 s90, s90, s66
    s_add_u32 s90, s90, 0x800000
    s_lshl_b32 s87, s67, 15
    s_lshl_b32 s66, s62, 13
    s_add_u32 s87, s87, s66
    s_add_u32 s87, s87, 0x600000
    s_lshl_b32 s88, s67, 15
    s_lshl_b32 s66, s61, 7
    s_add_u32 s88, s88, s66
    s_lshl_b32 s66, s62, 13
    s_add_u32 s88, s88, s66
    s_add_u32 s13, s87, 4096
    s_and_b32 s62, s22, 1
    s_lshr_b32 s63, s22, 1
    s_mul_i32 s62, s62, 69632
    s_mul_i32 s64, s63, 8448
    s_add_u32 s16, s64, s62
    s_lshl_b32 s64, s63, 7
    s_add_u32 s17, s64, s62
    s_setpc_b64 s[76:77]
L_OR0:
    s_sub_u32 s70, s70, 1
    s_cmp_lt_i32 s70, 0
    s_cbranch_scc1 L_OK0
    s_waitcnt vmcnt(0)
    s_sleep 2
    buffer_load_dwordx4 v[16:19], v95, s[32:35], s87 offen offset:0 sc1
    buffer_load_dwordx4 v[20:23], v95, s[32:35], s87 offen offset:1024 sc1
    buffer_load_dwordx4 v[24:27], v95, s[32:35], s87 offen offset:2048 sc1
    buffer_load_dwordx4 v[28:31], v95, s[32:35], s87 offen offset:3072 sc1
    buffer_load_dwordx4 v[32:35], v95, s[32:35], s13 offen offset:0 sc1
    buffer_load_dwordx4 v[36:39], v95, s[32:35], s13 offen offset:1024 sc1
    buffer_load_dwordx4 v[40:43], v95, s[32:35], s13 offen offset:2048 sc1
    buffer_load_dwordx4 v[44:47], v95, s[32:35], s13 offen offset:3072 sc1
    s_branch L_OW0
L_OR1:
    s_sub_u32 s70, s70, 1
    s_cmp_lt_i32 s70, 0
    s_cbranch_scc1 L_OK1
    s_waitcnt vmcnt(0)
    s_sleep 2
    buffer_load_dwordx4 v[20:23], v95, s[32:35], s87 offen offset:1024 sc1
    buffer_load_dwordx4 v[24:27], v95, s[32:35], s87 offen offset:2048 sc1
    buffer_load_dwordx4 v[28:31], v95, s[32:35], s87 offen offset:3072 sc1
    buffer_load_dwordx4 v[32:35], v95, s[32:35], s13 offen offset:0 sc1
    buffer_load_dwordx4 v[36:39], v95, s[32:35], s13 offen offset:1024 sc1
    buffer_load_dwordx4 v[40:43], v95, s[32:35], s13 offen offset:2048 sc1
    buffer_load_dwordx4 v[44:47], v95, s[32:35], s13 offen offset:3072 sc1
    s_branch L_OW1
L_OR2:
    s_sub_u32 s70, s70, 1
    s_cmp_lt_i32 s70, 0
    s_cbranch_scc1 L_OK2
    s_waitcnt vmcnt(0)
    s_sleep 2
    buffer_load_dwordx4 v[24:27], v95, s[32:35], s87 offen offset:2048 sc1
    buffer_load_dwordx4 v[28:31], v95, s[32:35], s87 offen offset:3072 sc1
    buffer_load_dwordx4 v[32:35], v95, s[32:35], s13 offen offset:0 sc1
    buffer_load_dwordx4 v[36:39], v95, s[32:35], s13 offen offset:1024 sc1
    buffer_load_dwordx4 v[40:43], v95, s[32:35], s13 offen offset:2048 sc1
    buffer_load_dwordx4 v[44:47], v95, s[32:35], s13 offen offset:3072 sc1
    s_branch L_OW2
L_OR3:
    s_sub_u32 s70, s70, 1
    s_cmp_lt_i32 s70, 0
    s_cbranch_scc1 L_OK3
    s_waitcnt vmcnt(0)
    s_sleep 2
    buffer_load_dwordx4 v[28:31], v95, s[32:35], s87 offen offset:3072 sc1
    buffer_load_dwordx4 v[32:35], v95, s[32:35], s13 offen offset:0 sc1
    buffer_load_dwordx4 v[36:39], v95, s[32:35], s13 offen offset:1024 sc1
    buffer_load_dwordx4 v[40:43], v95, s[32:35], s13 offen offset:2048 sc1
    buffer_load_dwordx4 v[44:47], v95, s[32:35], s13 offen offset:3072 sc1
    s_branch L_OW3
L_OR4:
    s_sub_u32 s70, s70, 1
    s_cmp_lt_i32 s70, 0
    s_cbranch_scc1 L_OK4
    s_waitcnt vmcnt(0)
    s_sleep 2
    buffer_load_dwordx4 v[32:35], v95, s[32:35], s13 offen offset:0 sc1
    buffer_load_dwordx4 v[36:39], v95, s[32:35], s13 offen offset:1024 sc1
    buffer_load_dwordx4 v[40:43], v95, s[32:35], s13 offen offset:2048 sc1
    buffer_load_dwordx4 v[44:47], v95, s[32:35], s13 offen offset:3072 sc1
    s_branch L_OW4
L_OR5:
    s_sub_u32 s70, s70, 1
    s_cmp_lt_i32 s70, 0
    s_cbranch_scc1 L_OK5
    s_waitcnt vmcnt(0)
    s_sleep 2
    buffer_load_dwordx4 v[36:39], v95, s[32:35], s13 offen offset:1024 sc1
    buffer_load_dwordx4 v[40:43], v95, s[32:35], s13 offen offset:2048 sc1
    buffer_load_dwordx4 v[44:47], v95, s[32:35], s13 offen offset:3072 sc1
    s_branch L_OW5
L_OR6:
    s_sub_u32 s70, s70, 1
    s_cmp_lt_i32 s70, 0
    s_cbranch_scc1 L_OK6
    s_waitcnt vmcnt(0)
    s_sleep 2
    buffer_load_dwordx4 v[40:43], v95, s[32:35], s13 offen offset:2048 sc1
    buffer_load_dwordx4 v[44:47], v95, s[32:35], s13 offen offset:3072 sc1
    s_branch L_OW6
L_OR7:
    s_sub_u32 s70, s70, 1
    s_cmp_lt_i32 s70, 0
    s_cbranch_scc1 L_OK7
    s_waitcnt vmcnt(0)
    s_sleep 2
    buffer_load_dwordx4 v[44:47], v95, s[32:35], s13 offen offset:3072 sc1
    s_branch L_OW7
L_EXACT:
    s_mov_b32 s82, 0
    s_and_b32 s95, s2, 31
    s_lshl_b32 s95, s95, 16
    s_add_u32 s95, s95, 0x200000
    s_add_u32 s94, s95, 63488
    v_add_u32 v94, 2031616, v98
    v_mov_b32 v100, 0xff800000
    v_mov_b32 v144, 0
    v_mov_b32 v145, 0
    v_mov_b32 v146, 0
    v_mov_b32 v147, 0
    v_mov_b32 v148, 0
    v_mov_b32 v149, 0
    v_mov_b32 v150, 0
    v_mov_b32 v151, 0
    v_mov_b32 v152, 0
    v_mov_b32 v153, 0
    v_mov_b32 v154, 0
    v_mov_b32 v155, 0
    v_mov_b32 v156, 0
    v_mov_b32 v157, 0
    v_mov_b32 v158, 0
    v_mov_b32 v159, 0
    v_mov_b32 v24, 0
    v_mov_b32 v25, 0
    v_mov_b32 v26, 0
    v_mov_b32 v27, 0
    v_mov_b32 v28, 0
    v_mov_b32 v29, 0
    v_mov_b32 v30, 0
    v_mov_b32 v31, 0
L_MAXLOOP:
    buffer_load_dwordx4 v[84:87], v95, s[32:35], s94 offen sc1
    buffer_load_dwordx4 v[88:91], v95, s[32:35], s94 offen offset:1024 sc1
    s_waitcnt vmcnt(0)
    v_mfma_f32_32x32x16_bf16 v[0:15], v[84:87], v[80:83], 0
    v_mfma_f32_32x32x16_bf16 v[32:47], v[88:91], v[80:83], 0
    s_nop 11
    v_max3_f32 v100, v0, v1, v100
    v_max3_f32 v100, v2, v3, v100
    v_max3_f32 v100, v4, v5, v100
    v_max3_f32 v100, v6, v7, v100
    v_max3_f32 v100, v8, v9, v100
    v_max3_f32 v100, v10, v11, v100
    v_max3_f32 v100, v12, v13, v100
    v_max3_f32 v100, v14, v15, v100
    v_max3_f32 v100, v32, v33, v100
    v_max3_f32 v100, v34, v35, v100
    v_max3_f32 v100, v36, v37, v100
    v_max3_f32 v100, v38, v39, v100
    v_max3_f32 v100, v40, v41, v100
    v_max3_f32 v100, v42, v43, v100
    v_max3_f32 v100, v44, v45, v100
    v_max3_f32 v100, v46, v47, v100
    s_cmp_eq_u32 s94, s95
    s_cbranch_scc1 L_MAXDONE
    s_sub_u32 s94, s94, 2048
    s_branch L_MAXLOOP
L_MAXDONE:
    v_mov_b32 v101, v100
    s_nop 1
    v_permlane32_swap_b32 v100, v101
    s_nop 1
    v_max_f32 v100, v100, v101
    v_sub_f32 v32, 0, v100
    v_sub_f32 v33, 0, v100
    v_sub_f32 v34, 0, v100
    v_sub_f32 v35, 0, v100
    v_sub_f32 v36, 0, v100
    v_sub_f32 v37, 0, v100
    v_sub_f32 v38, 0, v100
    v_sub_f32 v39, 0, v100
    v_sub_f32 v40, 0, v100
    v_sub_f32 v41, 0, v100
    v_sub_f32 v42, 0, v100
    v_sub_f32 v43, 0, v100
    v_sub_f32 v44, 0, v100
    v_sub_f32 v45, 0, v100
    v_sub_f32 v46, 0, v100
    v_sub_f32 v47, 0, v100
    s_nop 1
    v_mfma_f32_32x32x16_bf16 v[0:15], v[84:87], v[80:83], v[32:47]
    s_mov_b64 exec, s[80:81]
    buffer_load_dwordx4 v[160:163], v94, s[32:35], s94 offen sc1
    s_mov_b64 exec, -1
    buffer_load_dwordx4 v[84:87], v95, s[32:35], s94 offen offset:2048 sc1
    s_mov_b64 exec, s[80:81]
    buffer_load_dwordx4 v[164:167], v94, s[32:35], s94 offen offset:1024 sc1
    buffer_load_dwordx4 v[168:171], v94, s[32:35], s94 offen offset:512 sc1
    s_mov_b64 exec, -1
    s_mov_b32 s83, 0
    s_nop 4
L_LOOPP:
    s_setprio 3
    s_waitcnt vmcnt(3)
    v_exp_f32 v0, v0
    v_exp_f32 v1, v1
    v_smfmac_f32_32x32x32_bf16 v[144:159], v[172:175], v[24:31], v92
    v_exp_f32 v2, v2
    v_exp_f32 v3, v3
    v_exp_f32 v4, v4
    v_exp_f32 v5, v5
    v_exp_f32 v6, v6
    v_mfma_f32_32x32x16_bf16 v[16:31], v[88:91], v[80:83], v[32:47]
    buffer_load_dwordx4 v[88:91], v95, s[32:35], s94 offen offset:3072 sc1
    v_exp_f32 v7, v7
    v_exp_f32 v8, v8
    v_exp_f32 v9, v9
    v_exp_f32 v10, v10
    v_exp_f32 v11, v11
    v_smfmac_f32_32x32x32_bf16 v[144:159], v[160:163], v[0:7], v92
    s_mov_b64 exec, s[80:81]
    buffer_load_dwordx4 v[160:163], v94, s[32:35], s94 offen offset:2048 sc1
    buffer_load_dwordx4 v[172:175], v94, s[32:35], s94 offen offset:1536 sc1
    s_add_u32 s94, s94, 1024
    s_mov_b64 exec, -1
    v_exp_f32 v12, v12
    v_exp_f32 v13, v13
    v_exp_f32 v14, v14
    v_exp_f32 v15, v15
    s_waitcnt vmcnt(3)
    v_exp_f32 v16, v16
    v_exp_f32 v17, v17
    v_smfmac_f32_32x32x32_bf16 v[144:159], v[168:171], v[8:15], v92
    v_exp_f32 v18, v18
    v_exp_f32 v19, v19
    v_exp_f32 v20, v20
    v_exp_f32 v21, v21
    v_exp_f32 v22, v22
    v_mfma_f32_32x32x16_bf16 v[0:15], v[84:87], v[80:83], v[32:47]
    buffer_load_dwordx4 v[84:87], v95, s[32:35], s94 offen offset:3072 sc1
    v_exp_f32 v23, v23
    v_exp_f32 v24, v24
    v_exp_f32 v25, v25
    v_exp_f32 v26, v26
    v_exp_f32 v27, v27
    v_smfmac_f32_32x32x32_bf16 v[144:159], v[164:167], v[16:23], v92
    s_mov_b64 exec, s[80:81]
    buffer_load_dwordx4 v[164:167], v94, s[32:35], s94 offen offset:2048 sc1
    buffer_load_dwordx4 v[168:171], v94, s[32:35], s94 offen offset:1536 sc1
    s_add_u32 s94, s94, 1024
    s_mov_b64 exec, -1
    v_exp_f32 v28, v28
    v_exp_f32 v29, v29
    v_exp_f32 v30, v30
    v_exp_f32 v31, v31
    s_add_u32 s83, s83, 1
    s_cmp_lt_u32 s83, 32
    s_cbranch_scc1 L_LOOPP
    s_waitcnt vmcnt(0)
    s_branch L_ATT_DONE
L_CODE_END:
.section .rodata,"a"
.p2align 6
.amdhsa_kernel recurrent_scan__softmax_full_mha__glu_gated_geglu__prompt_kernel
  .amdhsa_next_free_vgpr 256
  .amdhsa_next_free_sgpr 102
  .amdhsa_accum_offset 256
  .amdhsa_group_segment_fixed_size 0
  .amdhsa_kernarg_size 80
  .amdhsa_user_sgpr_count 2
  .amdhsa_user_sgpr_kernarg_segment_ptr 1
  .amdhsa_system_sgpr_workgroup_id_x 1
.end_amdhsa_kernel
```
